```python
import torch

def _softmax(x, axis=-1):
    return torch.softmax(x, dim=axis)
def _gelu(x):
    return torch.nn.functional.gelu(x, approximate="tanh")
def _silu(x):
    return torch.nn.functional.silu(x)
def _sigmoid(x):
    return torch.sigmoid(x)
def _layernorm(x, axis=-1, eps=1e-5):
    m = x.mean(dim=axis, keepdim=True)
    v = x.var(dim=axis, keepdim=True, unbiased=False)
    return (x - m) / torch.sqrt(v + eps)
def _scatter_add(tgt, idx, src, axis=0):
    return tgt.clone().index_add_(axis, idx, src)
def _segment_sum(src, seg, n):
    out = torch.zeros((n,) + src.shape[1:], dtype=src.dtype)
    return out.index_add_(0, seg, src)
def _pad(x, pw):
    flat = tuple(v for pair in reversed(pw) for v in pair)
    return torch.nn.functional.pad(x, flat)

kernel_name = 'sequential_preLN__grouped_kv_mqa__dense_activation_squared_relu__prompt'

def setup_inputs():

    _w = (lambda a: (lambda t: t.to(torch.bfloat16) if t.is_floating_point() else t)(torch.as_tensor(a)))
    def _A_setup():
        B, S, D, H = 1, 2048, 576, 32
        Dh = D // H
        return {
            "x": _w((lambda *s: torch.randn(*s, dtype=torch.bfloat16) * 0.05)(B, S, D)),
            "wq": _w((lambda *s: torch.randn(*s, dtype=torch.bfloat16) * 0.05)(D, H * Dh)),
            "wk": _w((lambda *s: torch.randn(*s, dtype=torch.bfloat16) * 0.05)(D, Dh)),
            "wv": _w((lambda *s: torch.randn(*s, dtype=torch.bfloat16) * 0.05)(D, Dh)),
            "wo": _w((lambda *s: torch.randn(*s, dtype=torch.bfloat16) * 0.05)(H * Dh, D)),
        }
    _A_in = _A_setup()

    def _B_setup():
        B, S, D, F = 1, 2048, 576, 4608
        return {
            "x": _w((lambda *s: torch.randn(*s, dtype=torch.bfloat16) * 0.05)(B, S, D)),
            "w1": _w((lambda *s: torch.randn(*s, dtype=torch.bfloat16) * 0.05)(D, F)),
            "b1": _w((lambda *s: torch.randn(*s, dtype=torch.bfloat16) * 0.4)(F)),
            "w2": _w((lambda *s: torch.randn(*s, dtype=torch.bfloat16) * 0.05)(F, D)),
            "b2": _w((lambda *s: torch.randn(*s, dtype=torch.bfloat16) * 3.2)(D)),
        }
    _B_in = _B_setup()

    return {
        "A_x": _A_in["x"],
        "A_wq": _A_in["wq"],
        "A_wk": _A_in["wk"],
        "A_wv": _A_in["wv"],
        "A_wo": _A_in["wo"],
        "B_x": _B_in["x"],
        "B_w1": _B_in["w1"],
        "B_b1": _B_in["b1"],
        "B_w2": _B_in["w2"],
        "B_b2": _B_in["b2"],
    }

def reference(A_x, A_wq, A_wk, A_wv, A_wo, B_x, B_w1, B_b1, B_w2, B_b2):
    def _A_ref(x, wq, wk, wv, wo):
        B, S, D = x.shape
        H = 32
        Dh = D // H
        q = (lambda x, *d: x.permute(*d))((x @ wq).reshape(B, S, H, Dh), 0, 2, 1, 3)
        k = x @ wk
        v = x @ wv
        scores = torch.einsum("bhqd,bkd->bhqk", q, k) * (Dh ** -0.5)
        p = _softmax(scores, axis=-1)
        o = torch.einsum("bhqk,bkd->bhqd", p, v)
        return (lambda x, *d: x.permute(*d))(o, 0, 2, 1, 3).reshape(B, S, H * Dh) @ wo

    def _B_ref(x, w1, b1, w2, b2):
        h = torch.einsum("bsd,df->bsf", x, w1) + b1
        zero = torch.zeros_like(h)
        r = torch.where(h > zero, h, zero)
        h = r * r
        out = torch.einsum("bsf,fd->bsd", h, w2) + b2
        return out

    x = A_x
    h = x + _A_ref(_layernorm(x, axis=-1), A_wq, A_wk, A_wv, A_wo)
    h2 = h + _B_ref(_layernorm(h, axis=-1), B_w1, B_b1, B_w2, B_b2)
    return h2
```

```asm
; @launch kernel=attn_kernel grid=(256,1,1) block=(704,1,1) lds=163840
; @launch kernel=ffn_kernel grid=(256,1,1) block=(256,1,1) lds=158720
.amdgcn_target "amdgcn-amd-amdhsa--gfx950"
.text
.globl attn_kernel
.p2align 8
.type attn_kernel,@function
attn_kernel:
    s_cmp_ge_u32 s2, 256
    s_cbranch_scc1 L_attn_end
    s_getpc_b64 s[66:67]
    v_subrev_u32 v1, 576, v0
    s_cmp_lt_u32 s2, 128
    s_cbranch_scc1 L_attn_nopf
    v_cmp_gt_u32 vcc, 128, v1
    v_lshlrev_b32 v1, 7, v1
    s_and_saveexec_b64 s[68:69], vcc
    s_cbranch_execz L_attn_nopf
    global_load_dword v2, v1, s[66:67]
L_attn_nopf:
    s_mov_b64 exec, -1
    s_load_dwordx8 s[52:59], s[0:1], 0
    s_load_dwordx4 s[28:31], s[0:1], 88
    s_and_b32 s34, s2, 7
    s_lshr_b32 s35, s2, 3
    s_bfe_u32 s41, s35, 0x30001
    s_lshl_b32 s45, s41, 3
    s_add_u32 s45, s45, s34
    s_lshr_b32 s39, s35, 4
    s_lshl_b32 s39, s39, 1
    s_and_b32 s37, s35, 1
    s_add_u32 s39, s39, s37
    v_lshrrev_b32 v1, 6, v0
    v_and_b32 v18, 63, v0
    v_readfirstlane_b32 s38, v1
    v_and_b32 v3, 31, v18
    v_lshrrev_b32 v4, 5, v18
    v_lshlrev_b32 v7, 4, v18
    s_lshl_b32 s40, s39, 3
    s_add_u32 s40, s40, s38
    s_sub_u32 s42, s41, 6
    s_cmp_ge_u32 s41, 6
    s_cselect_b32 s41, s42, s41
    v_lshrrev_b32 v5, 4, v18
    v_and_b32 v6, 15, v18
    v_mul_u32_u24 v44, 1152, v5
    v_lshl_add_u32 v44, v6, 4, v44
    s_mul_i32 s47, s45, 36864
    s_mul_i32 s48, s38, 4608
    s_add_u32 s48, s48, s47
    v_mov_b32 v64, 0
    v_mov_b32 v65, 0
    v_mov_b32 v66, 0
    v_mov_b32 v67, 0
    v_mov_b32 v92, 163792
    ds_write_b128 v92, v[64:67]
    ds_write_b128 v92, v[64:67] offset:16
    ds_write_b128 v92, v[64:67] offset:32
    s_mov_b32 s14, 2359296
    s_mov_b32 s15, 0x00020000
    s_mov_b32 s26, 37625856
    s_mov_b32 s27, 0x00020000
    s_movk_i32 s6, 256
    s_mov_b32 s7, 0x00020000
    s_mov_b32 s62, 0x00ff00ff
    s_mov_b32 s63, 0x00ff00ff
    s_waitcnt lgkmcnt(0)
    s_mov_b32 s12, s52
    s_mov_b32 s13, s53
    s_cmp_ge_u32 s38, 8
    s_cbranch_scc1 L_attn_nox
    buffer_load_dwordx4 v[48:51], v44, s[12:15], s48 offen offset:0
    buffer_load_dwordx4 v[52:55], v44, s[12:15], s48 offen offset:256
    buffer_load_dwordx4 v[56:59], v44, s[12:15], s48 offen offset:512
    buffer_load_dwordx4 v[60:63], v44, s[12:15], s48 offen offset:768
    s_mov_b64 exec, s[62:63]
    buffer_load_dwordx4 v[64:67], v44, s[12:15], s48 offen offset:1024
    s_mov_b64 exec, -1
L_attn_nox:
    s_mov_b32 s24, s30
    s_mov_b32 s25, s31
    s_mov_b32 s4, s28
    s_mov_b32 s5, s29
    s_barrier
    s_cmp_eq_u32 s38, 8
    s_cbranch_scc1 L_attn_loader
    s_cmp_ge_u32 s38, 9
    s_cbranch_scc1 L_attn_prod
    s_setprio 3
    s_lshl_b32 s49, s38, 2
    v_add_u32 v5, s49, v5
    v_add_u32 v45, 0, v6
    v_mul_u32_u24 v46, 43, v45
    v_lshrrev_b32 v46, 9, v46
    v_mul_u32_u24 v46, 12, v46
    v_sub_u32 v46, v45, v46
    v_xor_b32 v46, v46, v5
    v_lshlrev_b32 v45, 9, v45
    v_lshl_add_u32 v70, v46, 4, v45
    v_add_u32 v45, 16, v6
    v_mul_u32_u24 v46, 43, v45
    v_lshrrev_b32 v46, 9, v46
    v_mul_u32_u24 v46, 12, v46
    v_sub_u32 v46, v45, v46
    v_xor_b32 v46, v46, v5
    v_lshlrev_b32 v45, 9, v45
    v_lshl_add_u32 v71, v46, 4, v45
    v_add_u32 v45, 32, v6
    v_mul_u32_u24 v46, 43, v45
    v_lshrrev_b32 v46, 9, v46
    v_mul_u32_u24 v46, 12, v46
    v_sub_u32 v46, v45, v46
    v_xor_b32 v46, v46, v5
    v_lshlrev_b32 v45, 9, v45
    v_lshl_add_u32 v72, v46, 4, v45
    v_add_u32 v45, 48, v6
    v_mul_u32_u24 v46, 43, v45
    v_lshrrev_b32 v46, 9, v46
    v_mul_u32_u24 v46, 12, v46
    v_sub_u32 v46, v45, v46
    v_xor_b32 v46, v46, v5
    v_lshlrev_b32 v45, 9, v45
    v_lshl_add_u32 v73, v46, 4, v45
    v_add_u32 v45, 64, v6
    v_mul_u32_u24 v46, 43, v45
    v_lshrrev_b32 v46, 9, v46
    v_mul_u32_u24 v46, 12, v46
    v_sub_u32 v46, v45, v46
    v_xor_b32 v46, v46, v5
    v_lshlrev_b32 v45, 9, v45
    v_lshl_add_u32 v74, v46, 4, v45
    s_mul_i32 s49, s41, 6144
    v_add_u32 v45, 0, v4
    v_xor_b32 v46, v45, v3
    v_lshlrev_b32 v45, 9, v45
    v_lshl_add_u32 v80, v46, 4, v45
    v_add_u32 v80, s49, v80
    v_add_u32 v45, 2, v4
    v_xor_b32 v46, v45, v3
    v_lshlrev_b32 v45, 9, v45
    v_lshl_add_u32 v81, v46, 4, v45
    v_add_u32 v81, s49, v81
    v_add_u32 v45, 4, v4
    v_xor_b32 v46, v45, v3
    v_lshlrev_b32 v45, 9, v45
    v_lshl_add_u32 v82, v46, 4, v45
    v_add_u32 v82, s49, v82
    v_add_u32 v45, 6, v4
    v_xor_b32 v46, v45, v3
    v_lshlrev_b32 v45, 9, v45
    v_lshl_add_u32 v83, v46, 4, v45
    v_add_u32 v83, s49, v83
    v_add_u32 v45, 8, v4
    v_xor_b32 v46, v45, v3
    v_lshlrev_b32 v45, 9, v45
    v_lshl_add_u32 v84, v46, 4, v45
    v_add_u32 v84, s49, v84
    v_add_u32 v45, 10, v4
    v_xor_b32 v46, v45, v3
    v_lshlrev_b32 v45, 9, v45
    v_lshl_add_u32 v85, v46, 4, v45
    v_add_u32 v85, s49, v85
    v_bfe_u32 v45, v18, 2, 2
    v_lshl_add_u32 v45, v4, 3, v45
    v_bfe_u32 v46, v18, 4, 1
    v_and_b32 v47, 3, v18
    v_lshlrev_b32 v47, 3, v47
    v_lshl_add_u32 v46, v46, 5, v47
    v_mul_u32_u24 v86, 288, v45
    v_add_u32 v86, v86, v46
    s_mul_i32 s49, s38, 36
    s_and_b32 s49, s49, 0xfff8
    s_add_u32 s49, s49, 64512
    v_add_u32 v86, s49, v86
    v_add_u32 v87, 55296, v86
    v_subrev_u32 v91, 64512, v86
    v_lshlrev_b32 v119, 2, v3
    v_add_u32 v119, 1024, v119
    v_mov_b32 v88, 163792
    v_mov_b32 v89, 1
    v_cmp_eq_u32 vcc, 22, v3
    v_mov_b32 v1, 18
    v_mul_u32_u24 v44, 19, v4
    v_cndmask_b32 v45, v3, v1, vcc
    v_add_u32 v45, v45, v44
    v_lshlrev_b32 v45, 4, v45
    v_add_u32 v120, 1152, v45
    v_cmp_eq_u32 vcc, 0, v4
    s_mov_b32 s74, 0x47ffff
    s_mov_b32 s75, 0x47ffff
    s_mov_b64 s[60:61], vcc
    v_mov_b32 v8, 0
    v_mov_b32 v9, 0
    v_mov_b32 v10, 0
    v_mov_b32 v11, 0
    s_mov_b32 s58, 0x3f803f80
    s_waitcnt vmcnt(4)
    v_dot2c_f32_bf16 v8, s58, v48
    v_dot2c_f32_bf16 v10, v48, v48
    v_dot2c_f32_bf16 v9, s58, v49
    v_dot2c_f32_bf16 v11, v49, v49
    v_dot2c_f32_bf16 v8, s58, v50
    v_dot2c_f32_bf16 v10, v50, v50
    v_dot2c_f32_bf16 v9, s58, v51
    v_dot2c_f32_bf16 v11, v51, v51
    s_waitcnt vmcnt(3)
    v_dot2c_f32_bf16 v8, s58, v52
    v_dot2c_f32_bf16 v10, v52, v52
    v_dot2c_f32_bf16 v9, s58, v53
    v_dot2c_f32_bf16 v11, v53, v53
    v_dot2c_f32_bf16 v8, s58, v54
    v_dot2c_f32_bf16 v10, v54, v54
    v_dot2c_f32_bf16 v9, s58, v55
    v_dot2c_f32_bf16 v11, v55, v55
    s_waitcnt vmcnt(2)
    v_dot2c_f32_bf16 v8, s58, v56
    v_dot2c_f32_bf16 v10, v56, v56
    v_dot2c_f32_bf16 v9, s58, v57
    v_dot2c_f32_bf16 v11, v57, v57
    v_dot2c_f32_bf16 v8, s58, v58
    v_dot2c_f32_bf16 v10, v58, v58
    v_dot2c_f32_bf16 v9, s58, v59
    v_dot2c_f32_bf16 v11, v59, v59
    s_waitcnt vmcnt(1)
    v_dot2c_f32_bf16 v8, s58, v60
    v_dot2c_f32_bf16 v10, v60, v60
    v_dot2c_f32_bf16 v9, s58, v61
    v_dot2c_f32_bf16 v11, v61, v61
    v_dot2c_f32_bf16 v8, s58, v62
    v_dot2c_f32_bf16 v10, v62, v62
    v_dot2c_f32_bf16 v9, s58, v63
    v_dot2c_f32_bf16 v11, v63, v63
    s_waitcnt vmcnt(0)
    v_dot2c_f32_bf16 v8, s58, v64
    v_dot2c_f32_bf16 v10, v64, v64
    v_dot2c_f32_bf16 v9, s58, v65
    v_dot2c_f32_bf16 v11, v65, v65
    v_dot2c_f32_bf16 v8, s58, v66
    v_dot2c_f32_bf16 v10, v66, v66
    v_dot2c_f32_bf16 v9, s58, v67
    v_dot2c_f32_bf16 v11, v67, v67
    s_nop 2
    v_add_f32 v8, v8, v9
    v_add_f32 v9, v10, v11
    s_mov_b32 s58, 0xffff0000
    s_nop 0
    v_add_f32_dpp v8, v8, v8 row_ror:1 row_mask:0xf bank_mask:0xf
    v_add_f32_dpp v9, v9, v9 row_ror:1 row_mask:0xf bank_mask:0xf
    s_nop 0
    v_add_f32_dpp v8, v8, v8 row_ror:2 row_mask:0xf bank_mask:0xf
    v_add_f32_dpp v9, v9, v9 row_ror:2 row_mask:0xf bank_mask:0xf
    s_nop 0
    v_add_f32_dpp v8, v8, v8 row_ror:4 row_mask:0xf bank_mask:0xf
    v_add_f32_dpp v9, v9, v9 row_ror:4 row_mask:0xf bank_mask:0xf
    s_nop 0
    v_add_f32_dpp v8, v8, v8 row_ror:8 row_mask:0xf bank_mask:0xf
    v_add_f32_dpp v9, v9, v9 row_ror:8 row_mask:0xf bank_mask:0xf
    v_mul_f32 v8, 0x3ae38e39, v8
    v_mul_f32 v9, 0x3ae38e39, v9
    v_fma_f32 v9, -v8, v8, v9
    v_max_f32 v9, 0, v9
    v_add_f32 v9, 0x3727c5ac, v9
    v_rsq_f32 v10, v9
    s_nop 0
    v_mul_f32 v12, v8, v10
    v_sub_f32 v12, 0, v12
    v_lshlrev_b32 v14, 16, v48
    v_and_b32 v15, s58, v48
    v_pk_fma_f32 v[14:15], v[14:15], v[10:11], v[12:13] op_sel_hi:[1,0,0]
    v_cvt_pk_bf16_f32 v48, v14, v15
    v_lshlrev_b32 v16, 16, v49
    v_and_b32 v17, s58, v49
    v_pk_fma_f32 v[16:17], v[16:17], v[10:11], v[12:13] op_sel_hi:[1,0,0]
    v_cvt_pk_bf16_f32 v49, v16, v17
    v_lshlrev_b32 v14, 16, v50
    v_and_b32 v15, s58, v50
    v_pk_fma_f32 v[14:15], v[14:15], v[10:11], v[12:13] op_sel_hi:[1,0,0]
    v_cvt_pk_bf16_f32 v50, v14, v15
    v_lshlrev_b32 v16, 16, v51
    v_and_b32 v17, s58, v51
    v_pk_fma_f32 v[16:17], v[16:17], v[10:11], v[12:13] op_sel_hi:[1,0,0]
    v_cvt_pk_bf16_f32 v51, v16, v17
    ds_write_b128 v70, v[48:51] offset:27648
    v_lshlrev_b32 v14, 16, v52
    v_and_b32 v15, s58, v52
    v_pk_fma_f32 v[14:15], v[14:15], v[10:11], v[12:13] op_sel_hi:[1,0,0]
    v_cvt_pk_bf16_f32 v52, v14, v15
    v_lshlrev_b32 v16, 16, v53
    v_and_b32 v17, s58, v53
    v_pk_fma_f32 v[16:17], v[16:17], v[10:11], v[12:13] op_sel_hi:[1,0,0]
    v_cvt_pk_bf16_f32 v53, v16, v17
    v_lshlrev_b32 v14, 16, v54
    v_and_b32 v15, s58, v54
    v_pk_fma_f32 v[14:15], v[14:15], v[10:11], v[12:13] op_sel_hi:[1,0,0]
    v_cvt_pk_bf16_f32 v54, v14, v15
    v_lshlrev_b32 v16, 16, v55
    v_and_b32 v17, s58, v55
    v_pk_fma_f32 v[16:17], v[16:17], v[10:11], v[12:13] op_sel_hi:[1,0,0]
    v_cvt_pk_bf16_f32 v55, v16, v17
    ds_write_b128 v71, v[52:55] offset:27648
    v_lshlrev_b32 v14, 16, v56
    v_and_b32 v15, s58, v56
    v_pk_fma_f32 v[14:15], v[14:15], v[10:11], v[12:13] op_sel_hi:[1,0,0]
    v_cvt_pk_bf16_f32 v56, v14, v15
    v_lshlrev_b32 v16, 16, v57
    v_and_b32 v17, s58, v57
    v_pk_fma_f32 v[16:17], v[16:17], v[10:11], v[12:13] op_sel_hi:[1,0,0]
    v_cvt_pk_bf16_f32 v57, v16, v17
    v_lshlrev_b32 v14, 16, v58
    v_and_b32 v15, s58, v58
    v_pk_fma_f32 v[14:15], v[14:15], v[10:11], v[12:13] op_sel_hi:[1,0,0]
    v_cvt_pk_bf16_f32 v58, v14, v15
    v_lshlrev_b32 v16, 16, v59
    v_and_b32 v17, s58, v59
    v_pk_fma_f32 v[16:17], v[16:17], v[10:11], v[12:13] op_sel_hi:[1,0,0]
    v_cvt_pk_bf16_f32 v59, v16, v17
    ds_write_b128 v72, v[56:59] offset:27648
    v_lshlrev_b32 v14, 16, v60
    v_and_b32 v15, s58, v60
    v_pk_fma_f32 v[14:15], v[14:15], v[10:11], v[12:13] op_sel_hi:[1,0,0]
    v_cvt_pk_bf16_f32 v60, v14, v15
    v_lshlrev_b32 v16, 16, v61
    v_and_b32 v17, s58, v61
    v_pk_fma_f32 v[16:17], v[16:17], v[10:11], v[12:13] op_sel_hi:[1,0,0]
    v_cvt_pk_bf16_f32 v61, v16, v17
    v_lshlrev_b32 v14, 16, v62
    v_and_b32 v15, s58, v62
    v_pk_fma_f32 v[14:15], v[14:15], v[10:11], v[12:13] op_sel_hi:[1,0,0]
    v_cvt_pk_bf16_f32 v62, v14, v15
    v_lshlrev_b32 v16, 16, v63
    v_and_b32 v17, s58, v63
    v_pk_fma_f32 v[16:17], v[16:17], v[10:11], v[12:13] op_sel_hi:[1,0,0]
    v_cvt_pk_bf16_f32 v63, v16, v17
    ds_write_b128 v73, v[60:63] offset:27648
    v_lshlrev_b32 v14, 16, v64
    v_and_b32 v15, s58, v64
    v_pk_fma_f32 v[14:15], v[14:15], v[10:11], v[12:13] op_sel_hi:[1,0,0]
    v_cvt_pk_bf16_f32 v64, v14, v15
    v_lshlrev_b32 v16, 16, v65
    v_and_b32 v17, s58, v65
    v_pk_fma_f32 v[16:17], v[16:17], v[10:11], v[12:13] op_sel_hi:[1,0,0]
    v_cvt_pk_bf16_f32 v65, v16, v17
    v_lshlrev_b32 v14, 16, v66
    v_and_b32 v15, s58, v66
    v_pk_fma_f32 v[14:15], v[14:15], v[10:11], v[12:13] op_sel_hi:[1,0,0]
    v_cvt_pk_bf16_f32 v66, v14, v15
    v_lshlrev_b32 v16, 16, v67
    v_and_b32 v17, s58, v67
    v_pk_fma_f32 v[16:17], v[16:17], v[10:11], v[12:13] op_sel_hi:[1,0,0]
    v_cvt_pk_bf16_f32 v67, v16, v17
    s_mov_b64 exec, s[62:63]
    ds_write_b128 v74, v[64:67] offset:27648
    s_mov_b64 exec, 1
    ds_add_u32 v88, v89 offset:12
    s_setprio 1
    s_mov_b64 exec, -1
L_attn_xn:
    ds_read_b32 v44, v88 offset:12
    s_waitcnt lgkmcnt(0)
    v_readfirstlane_b32 s49, v44
    s_nop 0
    s_cmp_lt_u32 s49, 8
    s_cbranch_scc1 L_attn_xn
    ds_read_b128 v[24:27], v80 offset:27648
    ds_read_b128 v[32:35], v81 offset:27648
    ds_read_b128 v[40:43], v82 offset:27648
    ds_read_b128 v[48:51], v83 offset:27648
    ds_read_b128 v[56:59], v84 offset:27648
    ds_read_b128 v[64:67], v85 offset:27648
L_attn_w0:
    ds_read_b32 v90, v88 offset:36
    s_waitcnt lgkmcnt(0)
    v_readfirstlane_b32 s49, v90
    s_nop 0
    s_cmp_gt_u32 s49, 0
    s_cbranch_scc1 L_attn_wx0
    s_sleep 1
    s_branch L_attn_w0
L_attn_wx0:
    ds_read_b64_tr_b16 v[20:21], v86 offset:0
    ds_read_b64_tr_b16 v[22:23], v86 offset:1152
    ds_read_b64_tr_b16 v[28:29], v86 offset:4608
    ds_read_b64_tr_b16 v[30:31], v86 offset:5760
    ds_read_b64_tr_b16 v[36:37], v86 offset:9216
    ds_read_b64_tr_b16 v[38:39], v86 offset:10368
    ds_read_b64_tr_b16 v[44:45], v86 offset:13824
    ds_read_b64_tr_b16 v[46:47], v86 offset:14976
    ds_read_b64_tr_b16 v[52:53], v86 offset:18432
    ds_read_b64_tr_b16 v[54:55], v86 offset:19584
    ds_read_b64_tr_b16 v[60:61], v86 offset:23040
    ds_read_b64_tr_b16 v[62:63], v86 offset:24192
    s_add_u32 s41, s41, 1
    s_movk_i32 s49, 6144
    s_cmp_eq_u32 s41, 6
    s_cselect_b32 s49, -30720, s49
    v_add_u32 v80, s49, v80
    v_add_u32 v81, s49, v81
    v_add_u32 v82, s49, v82
    v_add_u32 v83, s49, v83
    v_add_u32 v84, s49, v84
    v_add_u32 v85, s49, v85
    s_waitcnt lgkmcnt(10)
    v_mfma_f32_32x32x16_bf16 v[96:111], v[20:23], v[24:27], 0
    s_waitcnt lgkmcnt(8)
    v_mfma_f32_32x32x16_bf16 v[96:111], v[28:31], v[32:35], v[96:111]
    ds_read_b128 v[24:27], v80 offset:27648
    s_waitcnt lgkmcnt(7)
    v_mfma_f32_32x32x16_bf16 v[96:111], v[36:39], v[40:43], v[96:111]
    ds_read_b128 v[32:35], v81 offset:27648
    s_waitcnt lgkmcnt(6)
    v_mfma_f32_32x32x16_bf16 v[96:111], v[44:47], v[48:51], v[96:111]
    ds_read_b128 v[40:43], v82 offset:27648
    s_waitcnt lgkmcnt(5)
    v_mfma_f32_32x32x16_bf16 v[96:111], v[52:55], v[56:59], v[96:111]
    ds_read_b128 v[48:51], v83 offset:27648
    s_waitcnt lgkmcnt(4)
    v_mfma_f32_32x32x16_bf16 v[96:111], v[60:63], v[64:67], v[96:111]
    ds_read_b128 v[56:59], v84 offset:27648
    ds_read_b128 v[64:67], v85 offset:27648
    s_mov_b64 exec, 1
    ds_add_u32 v88, v89 offset:0
    s_mov_b64 exec, -1
L_attn_w1:
    ds_read_b32 v90, v88 offset:36
    s_waitcnt lgkmcnt(0)
    v_readfirstlane_b32 s49, v90
    s_nop 0
    s_cmp_gt_u32 s49, 1
    s_cbranch_scc1 L_attn_wx1
    s_sleep 1
    s_branch L_attn_w1
L_attn_wx1:
    ds_read_b64_tr_b16 v[20:21], v86 offset:27648
    ds_read_b64_tr_b16 v[22:23], v86 offset:28800
    ds_read_b64_tr_b16 v[28:29], v86 offset:32256
    ds_read_b64_tr_b16 v[30:31], v86 offset:33408
    ds_read_b64_tr_b16 v[36:37], v86 offset:36864
    ds_read_b64_tr_b16 v[38:39], v86 offset:38016
    ds_read_b64_tr_b16 v[44:45], v86 offset:41472
    ds_read_b64_tr_b16 v[46:47], v86 offset:42624
    ds_read_b64_tr_b16 v[52:53], v86 offset:46080
    ds_read_b64_tr_b16 v[54:55], v86 offset:47232
    ds_read_b64_tr_b16 v[60:61], v86 offset:50688
    ds_read_b64_tr_b16 v[62:63], v86 offset:51840
    s_add_u32 s41, s41, 1
    s_movk_i32 s49, 6144
    s_cmp_eq_u32 s41, 6
    s_cselect_b32 s49, -30720, s49
    v_add_u32 v80, s49, v80
    v_add_u32 v81, s49, v81
    v_add_u32 v82, s49, v82
    v_add_u32 v83, s49, v83
    v_add_u32 v84, s49, v84
    v_add_u32 v85, s49, v85
    s_waitcnt lgkmcnt(10)
    v_mfma_f32_32x32x16_bf16 v[96:111], v[20:23], v[24:27], v[96:111]
    s_waitcnt lgkmcnt(8)
    v_mfma_f32_32x32x16_bf16 v[96:111], v[28:31], v[32:35], v[96:111]
    ds_read_b128 v[24:27], v80 offset:27648
    s_waitcnt lgkmcnt(7)
    v_mfma_f32_32x32x16_bf16 v[96:111], v[36:39], v[40:43], v[96:111]
    ds_read_b128 v[32:35], v81 offset:27648
    s_waitcnt lgkmcnt(6)
    v_mfma_f32_32x32x16_bf16 v[96:111], v[44:47], v[48:51], v[96:111]
    ds_read_b128 v[40:43], v82 offset:27648
    s_waitcnt lgkmcnt(5)
    v_mfma_f32_32x32x16_bf16 v[96:111], v[52:55], v[56:59], v[96:111]
    ds_read_b128 v[48:51], v83 offset:27648
    s_waitcnt lgkmcnt(4)
    v_mfma_f32_32x32x16_bf16 v[96:111], v[60:63], v[64:67], v[96:111]
    ds_read_b128 v[56:59], v84 offset:27648
    ds_read_b128 v[64:67], v85 offset:27648
    s_mov_b64 exec, 1
    ds_add_u32 v88, v89 offset:4
    s_mov_b64 exec, -1
L_attn_w2:
    ds_read_b32 v90, v88 offset:36
    s_waitcnt lgkmcnt(0)
    v_readfirstlane_b32 s49, v90
    s_nop 0
    s_cmp_gt_u32 s49, 2
    s_cbranch_scc1 L_attn_wx2
    s_sleep 1
    s_branch L_attn_w2
L_attn_wx2:
    ds_read_b64_tr_b16 v[20:21], v87 offset:0
    ds_read_b64_tr_b16 v[22:23], v87 offset:1152
    ds_read_b64_tr_b16 v[28:29], v87 offset:4608
    ds_read_b64_tr_b16 v[30:31], v87 offset:5760
    ds_read_b64_tr_b16 v[36:37], v87 offset:9216
    ds_read_b64_tr_b16 v[38:39], v87 offset:10368
    ds_read_b64_tr_b16 v[44:45], v87 offset:13824
    ds_read_b64_tr_b16 v[46:47], v87 offset:14976
    ds_read_b64_tr_b16 v[52:53], v87 offset:18432
    ds_read_b64_tr_b16 v[54:55], v87 offset:19584
    ds_read_b64_tr_b16 v[60:61], v87 offset:23040
    ds_read_b64_tr_b16 v[62:63], v87 offset:24192
    s_add_u32 s41, s41, 1
    s_movk_i32 s49, 6144
    s_cmp_eq_u32 s41, 6
    s_cselect_b32 s49, -30720, s49
    v_add_u32 v80, s49, v80
    v_add_u32 v81, s49, v81
    v_add_u32 v82, s49, v82
    v_add_u32 v83, s49, v83
    v_add_u32 v84, s49, v84
    v_add_u32 v85, s49, v85
    s_waitcnt lgkmcnt(10)
    v_mfma_f32_32x32x16_bf16 v[96:111], v[20:23], v[24:27], v[96:111]
    s_waitcnt lgkmcnt(8)
    v_mfma_f32_32x32x16_bf16 v[96:111], v[28:31], v[32:35], v[96:111]
    ds_read_b128 v[24:27], v80 offset:27648
    s_waitcnt lgkmcnt(7)
    v_mfma_f32_32x32x16_bf16 v[96:111], v[36:39], v[40:43], v[96:111]
    ds_read_b128 v[32:35], v81 offset:27648
    s_waitcnt lgkmcnt(6)
    v_mfma_f32_32x32x16_bf16 v[96:111], v[44:47], v[48:51], v[96:111]
    ds_read_b128 v[40:43], v82 offset:27648
    s_waitcnt lgkmcnt(5)
    v_mfma_f32_32x32x16_bf16 v[96:111], v[52:55], v[56:59], v[96:111]
    ds_read_b128 v[48:51], v83 offset:27648
    s_waitcnt lgkmcnt(4)
    v_mfma_f32_32x32x16_bf16 v[96:111], v[60:63], v[64:67], v[96:111]
    ds_read_b128 v[56:59], v84 offset:27648
    ds_read_b128 v[64:67], v85 offset:27648
L_attn_w3:
    ds_read_b32 v90, v88 offset:36
    s_waitcnt lgkmcnt(0)
    v_readfirstlane_b32 s49, v90
    s_nop 0
    s_cmp_gt_u32 s49, 3
    s_cbranch_scc1 L_attn_wx3
    s_sleep 1
    s_branch L_attn_w3
L_attn_wx3:
    ds_read_b64_tr_b16 v[20:21], v91 offset:0
    ds_read_b64_tr_b16 v[22:23], v91 offset:1152
    ds_read_b64_tr_b16 v[28:29], v91 offset:4608
    ds_read_b64_tr_b16 v[30:31], v91 offset:5760
    ds_read_b64_tr_b16 v[36:37], v91 offset:9216
    ds_read_b64_tr_b16 v[38:39], v91 offset:10368
    ds_read_b64_tr_b16 v[44:45], v91 offset:13824
    ds_read_b64_tr_b16 v[46:47], v91 offset:14976
    ds_read_b64_tr_b16 v[52:53], v91 offset:18432
    ds_read_b64_tr_b16 v[54:55], v91 offset:19584
    ds_read_b64_tr_b16 v[60:61], v91 offset:23040
    ds_read_b64_tr_b16 v[62:63], v91 offset:24192
    s_add_u32 s41, s41, 1
    s_movk_i32 s49, 6144
    s_cmp_eq_u32 s41, 6
    s_cselect_b32 s49, -30720, s49
    v_add_u32 v80, s49, v80
    v_add_u32 v81, s49, v81
    v_add_u32 v82, s49, v82
    v_add_u32 v83, s49, v83
    v_add_u32 v84, s49, v84
    v_add_u32 v85, s49, v85
    s_waitcnt lgkmcnt(10)
    v_mfma_f32_32x32x16_bf16 v[96:111], v[20:23], v[24:27], v[96:111]
    s_waitcnt lgkmcnt(8)
    v_mfma_f32_32x32x16_bf16 v[96:111], v[28:31], v[32:35], v[96:111]
    ds_read_b128 v[24:27], v80 offset:27648
    s_waitcnt lgkmcnt(7)
    v_mfma_f32_32x32x16_bf16 v[96:111], v[36:39], v[40:43], v[96:111]
    ds_read_b128 v[32:35], v81 offset:27648
    s_waitcnt lgkmcnt(6)
    v_mfma_f32_32x32x16_bf16 v[96:111], v[44:47], v[48:51], v[96:111]
    ds_read_b128 v[40:43], v82 offset:27648
    s_waitcnt lgkmcnt(5)
    v_mfma_f32_32x32x16_bf16 v[96:111], v[52:55], v[56:59], v[96:111]
    ds_read_b128 v[48:51], v83 offset:27648
    s_waitcnt lgkmcnt(4)
    v_mfma_f32_32x32x16_bf16 v[96:111], v[60:63], v[64:67], v[96:111]
    ds_read_b128 v[56:59], v84 offset:27648
    ds_read_b128 v[64:67], v85 offset:27648
    s_mov_b64 exec, 1
    ds_add_u32 v88, v89 offset:8
    s_mov_b64 exec, -1
L_attn_w4:
    ds_read_b32 v90, v88 offset:36
    s_waitcnt lgkmcnt(0)
    v_readfirstlane_b32 s49, v90
    s_nop 0
    s_cmp_gt_u32 s49, 4
    s_cbranch_scc1 L_attn_wx4
    s_sleep 1
    s_branch L_attn_w4
L_attn_wx4:
    ds_read_b64_tr_b16 v[20:21], v86 offset:0
    ds_read_b64_tr_b16 v[22:23], v86 offset:1152
    ds_read_b64_tr_b16 v[28:29], v86 offset:4608
    ds_read_b64_tr_b16 v[30:31], v86 offset:5760
    ds_read_b64_tr_b16 v[36:37], v86 offset:9216
    ds_read_b64_tr_b16 v[38:39], v86 offset:10368
    ds_read_b64_tr_b16 v[44:45], v86 offset:13824
    ds_read_b64_tr_b16 v[46:47], v86 offset:14976
    ds_read_b64_tr_b16 v[52:53], v86 offset:18432
    ds_read_b64_tr_b16 v[54:55], v86 offset:19584
    ds_read_b64_tr_b16 v[60:61], v86 offset:23040
    ds_read_b64_tr_b16 v[62:63], v86 offset:24192
    s_add_u32 s41, s41, 1
    s_movk_i32 s49, 6144
    s_cmp_eq_u32 s41, 6
    s_cselect_b32 s49, -30720, s49
    v_add_u32 v80, s49, v80
    v_add_u32 v81, s49, v81
    v_add_u32 v82, s49, v82
    v_add_u32 v83, s49, v83
    v_add_u32 v84, s49, v84
    v_add_u32 v85, s49, v85
    s_waitcnt lgkmcnt(10)
    v_mfma_f32_32x32x16_bf16 v[96:111], v[20:23], v[24:27], v[96:111]
    s_waitcnt lgkmcnt(8)
    v_mfma_f32_32x32x16_bf16 v[96:111], v[28:31], v[32:35], v[96:111]
    ds_read_b128 v[24:27], v80 offset:27648
    s_waitcnt lgkmcnt(7)
    v_mfma_f32_32x32x16_bf16 v[96:111], v[36:39], v[40:43], v[96:111]
    ds_read_b128 v[32:35], v81 offset:27648
    s_waitcnt lgkmcnt(6)
    v_mfma_f32_32x32x16_bf16 v[96:111], v[44:47], v[48:51], v[96:111]
    ds_read_b128 v[40:43], v82 offset:27648
    s_waitcnt lgkmcnt(5)
    v_mfma_f32_32x32x16_bf16 v[96:111], v[52:55], v[56:59], v[96:111]
    ds_read_b128 v[48:51], v83 offset:27648
    s_waitcnt lgkmcnt(4)
    v_mfma_f32_32x32x16_bf16 v[96:111], v[60:63], v[64:67], v[96:111]
    ds_read_b128 v[56:59], v84 offset:27648
    ds_read_b128 v[64:67], v85 offset:27648
L_attn_w5:
    ds_read_b32 v90, v88 offset:36
    s_waitcnt lgkmcnt(0)
    v_readfirstlane_b32 s49, v90
    s_nop 0
    s_cmp_gt_u32 s49, 5
    s_cbranch_scc1 L_attn_wx5
    s_sleep 1
    s_branch L_attn_w5
L_attn_wx5:
    ds_read_b64_tr_b16 v[20:21], v86 offset:27648
    ds_read_b64_tr_b16 v[22:23], v86 offset:28800
    ds_read_b64_tr_b16 v[28:29], v86 offset:32256
    ds_read_b64_tr_b16 v[30:31], v86 offset:33408
    ds_read_b64_tr_b16 v[36:37], v86 offset:36864
    ds_read_b64_tr_b16 v[38:39], v86 offset:38016
    ds_read_b64_tr_b16 v[44:45], v86 offset:41472
    ds_read_b64_tr_b16 v[46:47], v86 offset:42624
    ds_read_b64_tr_b16 v[52:53], v86 offset:46080
    ds_read_b64_tr_b16 v[54:55], v86 offset:47232
    ds_read_b64_tr_b16 v[60:61], v86 offset:50688
    ds_read_b64_tr_b16 v[62:63], v86 offset:51840
    s_waitcnt lgkmcnt(10)
    v_mfma_f32_32x32x16_bf16 v[96:111], v[20:23], v[24:27], v[96:111]
    s_waitcnt lgkmcnt(8)
    v_mfma_f32_32x32x16_bf16 v[96:111], v[28:31], v[32:35], v[96:111]
    s_waitcnt lgkmcnt(6)
    v_mfma_f32_32x32x16_bf16 v[96:111], v[36:39], v[40:43], v[96:111]
    s_waitcnt lgkmcnt(4)
    v_mfma_f32_32x32x16_bf16 v[96:111], v[44:47], v[48:51], v[96:111]
    s_waitcnt lgkmcnt(2)
    v_mfma_f32_32x32x16_bf16 v[96:111], v[52:55], v[56:59], v[96:111]
    s_waitcnt lgkmcnt(0)
    v_mfma_f32_32x32x16_bf16 v[96:111], v[60:63], v[64:67], v[96:111]
    s_mul_i32 s49, s38, 1536
    s_add_u32 s49, s49, 147456
    v_mul_u32_u24 v44, 48, v3
    v_add_u32 v44, s49, v44
    v_lshl_add_u32 v45, v4, 3, v44
    s_and_b32 s49, s38, 1
    s_lshl_b32 s49, s49, 2
    v_add_u32 v44, s49, v44
    v_lshl_add_u32 v46, v4, 4, v44
    s_mov_b32 s58, 0x3eae1a93
    s_nop 3
    v_mul_f32 v96, s58, v96
    v_mul_f32 v97, s58, v97
    v_mul_f32 v98, s58, v98
    v_mul_f32 v99, s58, v99
    v_mul_f32 v100, s58, v100
    v_mul_f32 v101, s58, v101
    v_mul_f32 v102, s58, v102
    v_mul_f32 v103, s58, v103
    v_mul_f32 v104, s58, v104
    v_mul_f32 v105, s58, v105
    v_mul_f32 v106, s58, v106
    v_mul_f32 v107, s58, v107
    v_cvt_pk_bf16_f32 v48, v96, v97
    v_cvt_pk_bf16_f32 v49, v98, v99
    v_cvt_pk_bf16_f32 v50, v100, v101
    v_cvt_pk_bf16_f32 v51, v102, v103
    v_cvt_pk_bf16_f32 v52, v104, v105
    v_cvt_pk_bf16_f32 v53, v106, v107
    ds_write_b64 v45, v[48:49] offset:0
    ds_write_b64 v45, v[50:51] offset:16
    ds_write_b64 v45, v[52:53] offset:32
    ds_read2_b32 v[8:9], v46 offset0:0 offset1:1
    ds_read2_b32 v[10:11], v46 offset0:2 offset1:3
    ds_read_b32 v12, v44 offset:32
    v_mov_b32 v96, 0
    v_mov_b32 v97, 0
    v_mov_b32 v98, 0
    v_mov_b32 v99, 0
    v_mov_b32 v100, 0
    v_mov_b32 v101, 0
    v_mov_b32 v102, 0
    v_mov_b32 v103, 0
    v_mov_b32 v104, 0
    v_mov_b32 v105, 0
    v_mov_b32 v106, 0
    v_mov_b32 v107, 0
    v_mov_b32 v108, 0
    v_mov_b32 v109, 0
    v_mov_b32 v110, 0
    v_mov_b32 v111, 0
    v_mov_b32 v84, 0
    v_mov_b32 v85, 0
    v_mov_b32 v86, 0
    v_mov_b32 v87, 0
    v_mov_b32 v28, 0
    v_mov_b32 v29, 0
    v_mov_b32 v30, 0
    v_mov_b32 v31, 0
    v_mov_b32 v32, 0
    v_mov_b32 v33, 0
    v_mov_b32 v34, 0
    v_mov_b32 v35, 0
    v_mov_b32 v36, 0
    v_mov_b32 v37, 0
    v_mov_b32 v38, 0
    v_mov_b32 v39, 0
    v_mov_b32 v40, 0
    v_mov_b32 v41, 0
    v_mov_b32 v42, 0
    v_mov_b32 v43, 0
    v_mov_b32 v1, v7
    v_mov_b32 v2, v119
    v_mov_b32 v3, v120
    v_mov_b32 v15, 0x3f803f80
    v_mov_b32 v17, 0x3f803f80
    v_mov_b32 v44, 0
    v_mov_b32 v47, 163824
    s_waitcnt lgkmcnt(0)
    v_cndmask_b32 v12, v44, v12, s[60:61]
    v_dot2c_f32_bf16 v44, v8, v8
    v_dot2c_f32_bf16 v44, v9, v9
    v_dot2c_f32_bf16 v44, v10, v10
    v_dot2c_f32_bf16 v44, v11, v11
    v_dot2c_f32_bf16 v44, v12, v12
    s_mov_b32 s70, 0
    s_setprio 3
    s_nop 1
    v_mov_b32 v45, v44
    s_nop 1
    v_permlane32_swap_b32 v44, v45
    v_add_f32 v44, v44, v45
    s_barrier
    ds_read_b32 v45, v47
    ds_read_b128 v[20:23], v1 offset:0
    ds_read_b32 v14, v2 offset:0
    ds_read_b128 v[24:27], v1 offset:2368
    ds_read_b32 v16, v2 offset:2368
    s_mov_b64 exec, s[74:75]
    ds_read_b128 v[28:31], v3 offset:0
    ds_read_b128 v[32:35], v3 offset:608
    s_mov_b64 exec, -1
    s_waitcnt lgkmcnt(6)
    v_mul_f32 v44, v44, v45
    v_sqrt_f32 v44, v44
    s_nop 0
    v_mul_f32 v44, 0xbf828f5c, v44
L_attn_setshift:
    v_and_b32 v45, 0xffff0000, v44
    v_sub_f32 v46, v44, v45
    v_and_b32 v47, 0xffff0000, v46
    v_sub_f32 v46, v46, v47
    v_lshrrev_b32 v45, 16, v45
    v_or_b32 v45, v45, v47
    v_lshrrev_b32 v46, 16, v46
    v_cndmask_b32 v13, v46, v45, s[60:61]
    s_waitcnt lgkmcnt(4)
    s_nop 0
    v_mfma_f32_32x32x8_bf16 v[48:63], v[14:15], v[12:13], 0
    v_mfma_f32_32x32x16_bf16 v[48:63], v[20:23], v[8:11], v[48:63]
    s_mov_b32 s71, 0
    s_nop 9
.p2align 6
L_attn_loop:
    s_waitcnt lgkmcnt(0)
    v_mfma_f32_32x32x8_bf16 v[64:79], v[16:17], v[12:13], 0
    v_exp_f32 v48, v48
    v_exp_f32 v49, v49
    v_exp_f32 v50, v50
    v_cvt_pk_bf16_f32 v80, v48, v49
    v_exp_f32 v51, v51
    v_mfma_f32_32x32x16_bf16 v[96:111], v[40:43], v[84:87], v[96:111]
    s_mov_b64 exec, s[74:75]
    ds_read_b128 v[36:39], v3 offset:2368
    ds_read_b128 v[40:43], v3 offset:2976
    s_mov_b64 exec, -1
    ds_read_b128 v[20:23], v1 offset:4736
    ds_read_b32 v14, v2 offset:4736
    v_exp_f32 v52, v52
    v_cvt_pk_bf16_f32 v81, v50, v51
    v_exp_f32 v53, v53
    v_exp_f32 v54, v54
    v_cvt_pk_bf16_f32 v82, v52, v53
    v_exp_f32 v55, v55
    v_mfma_f32_32x32x16_bf16 v[64:79], v[24:27], v[8:11], v[64:79]
    v_exp_f32 v56, v56
    v_cvt_pk_bf16_f32 v83, v54, v55
    v_exp_f32 v57, v57
    v_exp_f32 v58, v58
    v_cvt_pk_bf16_f32 v84, v56, v57
    v_exp_f32 v59, v59
    v_mfma_f32_32x32x16_bf16 v[96:111], v[28:31], v[80:83], v[96:111]
    v_exp_f32 v60, v60
    v_cvt_pk_bf16_f32 v85, v58, v59
    v_exp_f32 v61, v61
    v_exp_f32 v62, v62
    v_exp_f32 v63, v63
    v_cvt_pk_bf16_f32 v86, v60, v61
    v_cvt_pk_bf16_f32 v87, v62, v63
    s_waitcnt lgkmcnt(0)
    v_mfma_f32_32x32x8_bf16 v[48:63], v[14:15], v[12:13], 0
    v_exp_f32 v64, v64
    v_exp_f32 v65, v65
    v_exp_f32 v66, v66
    v_cvt_pk_bf16_f32 v80, v64, v65
    v_exp_f32 v67, v67
    v_mfma_f32_32x32x16_bf16 v[96:111], v[32:35], v[84:87], v[96:111]
    s_mov_b64 exec, s[74:75]
    ds_read_b128 v[28:31], v3 offset:4736
    ds_read_b128 v[32:35], v3 offset:5344
    s_mov_b64 exec, -1
    ds_read_b128 v[24:27], v1 offset:7104
    ds_read_b32 v16, v2 offset:7104
    v_exp_f32 v68, v68
    v_cvt_pk_bf16_f32 v81, v66, v67
    v_exp_f32 v69, v69
    v_exp_f32 v70, v70
    v_cvt_pk_bf16_f32 v82, v68, v69
    v_exp_f32 v71, v71
    v_mfma_f32_32x32x16_bf16 v[48:63], v[20:23], v[8:11], v[48:63]
    v_exp_f32 v72, v72
    v_cvt_pk_bf16_f32 v83, v70, v71
    v_exp_f32 v73, v73
    v_exp_f32 v74, v74
    v_cvt_pk_bf16_f32 v84, v72, v73
    v_exp_f32 v75, v75
    v_mfma_f32_32x32x16_bf16 v[96:111], v[36:39], v[80:83], v[96:111]
    v_exp_f32 v76, v76
    v_cvt_pk_bf16_f32 v85, v74, v75
    v_exp_f32 v77, v77
    v_exp_f32 v78, v78
    v_exp_f32 v79, v79
    v_cvt_pk_bf16_f32 v86, v76, v77
    v_cvt_pk_bf16_f32 v87, v78, v79
    s_waitcnt lgkmcnt(0)
    v_mfma_f32_32x32x8_bf16 v[64:79], v[16:17], v[12:13], 0
    v_exp_f32 v48, v48
    v_exp_f32 v49, v49
    v_exp_f32 v50, v50
    v_cvt_pk_bf16_f32 v80, v48, v49
    v_exp_f32 v51, v51
    v_mfma_f32_32x32x16_bf16 v[96:111], v[40:43], v[84:87], v[96:111]
    s_mov_b64 exec, s[74:75]
    ds_read_b128 v[36:39], v3 offset:7104
    ds_read_b128 v[40:43], v3 offset:7712
    s_mov_b64 exec, -1
    ds_read_b128 v[20:23], v1 offset:9472
    ds_read_b32 v14, v2 offset:9472
    v_exp_f32 v52, v52
    v_cvt_pk_bf16_f32 v81, v50, v51
    v_exp_f32 v53, v53
    v_exp_f32 v54, v54
    v_cvt_pk_bf16_f32 v82, v52, v53
    v_exp_f32 v55, v55
    v_mfma_f32_32x32x16_bf16 v[64:79], v[24:27], v[8:11], v[64:79]
    v_exp_f32 v56, v56
    v_cvt_pk_bf16_f32 v83, v54, v55
    v_exp_f32 v57, v57
    v_exp_f32 v58, v58
    v_cvt_pk_bf16_f32 v84, v56, v57
    v_exp_f32 v59, v59
    v_mfma_f32_32x32x16_bf16 v[96:111], v[28:31], v[80:83], v[96:111]
    v_exp_f32 v60, v60
    v_cvt_pk_bf16_f32 v85, v58, v59
    v_exp_f32 v61, v61
    v_exp_f32 v62, v62
    v_exp_f32 v63, v63
    v_cvt_pk_bf16_f32 v86, v60, v61
    v_cvt_pk_bf16_f32 v87, v62, v63
    s_waitcnt lgkmcnt(0)
    v_mfma_f32_32x32x8_bf16 v[48:63], v[14:15], v[12:13], 0
    v_exp_f32 v64, v64
    v_exp_f32 v65, v65
    v_exp_f32 v66, v66
    v_cvt_pk_bf16_f32 v80, v64, v65
    v_exp_f32 v67, v67
    v_mfma_f32_32x32x16_bf16 v[96:111], v[32:35], v[84:87], v[96:111]
    s_mov_b64 exec, s[74:75]
    ds_read_b128 v[28:31], v3 offset:9472
    ds_read_b128 v[32:35], v3 offset:10080
    s_mov_b64 exec, -1
    ds_read_b128 v[24:27], v1 offset:11840
    ds_read_b32 v16, v2 offset:11840
    v_exp_f32 v68, v68
    v_cvt_pk_bf16_f32 v81, v66, v67
    v_exp_f32 v69, v69
    v_exp_f32 v70, v70
    v_cvt_pk_bf16_f32 v82, v68, v69
    v_exp_f32 v71, v71
    v_mfma_f32_32x32x16_bf16 v[48:63], v[20:23], v[8:11], v[48:63]
    v_exp_f32 v72, v72
    v_cvt_pk_bf16_f32 v83, v70, v71
    v_exp_f32 v73, v73
    v_exp_f32 v74, v74
    v_cvt_pk_bf16_f32 v84, v72, v73
    v_exp_f32 v75, v75
    v_mfma_f32_32x32x16_bf16 v[96:111], v[36:39], v[80:83], v[96:111]
    v_exp_f32 v76, v76
    v_cvt_pk_bf16_f32 v85, v74, v75
    v_exp_f32 v77, v77
    v_exp_f32 v78, v78
    v_exp_f32 v79, v79
    v_cvt_pk_bf16_f32 v86, v76, v77
    v_cvt_pk_bf16_f32 v87, v78, v79
    s_waitcnt lgkmcnt(0)
    v_mfma_f32_32x32x8_bf16 v[64:79], v[16:17], v[12:13], 0
    v_exp_f32 v48, v48
    v_exp_f32 v49, v49
    v_exp_f32 v50, v50
    v_cvt_pk_bf16_f32 v80, v48, v49
    v_exp_f32 v51, v51
    v_mfma_f32_32x32x16_bf16 v[96:111], v[40:43], v[84:87], v[96:111]
    s_mov_b64 exec, s[74:75]
    ds_read_b128 v[36:39], v3 offset:11840
    ds_read_b128 v[40:43], v3 offset:12448
    s_mov_b64 exec, -1
    ds_read_b128 v[20:23], v1 offset:14208
    ds_read_b32 v14, v2 offset:14208
    v_exp_f32 v52, v52
    v_cvt_pk_bf16_f32 v81, v50, v51
    v_exp_f32 v53, v53
    v_exp_f32 v54, v54
    v_cvt_pk_bf16_f32 v82, v52, v53
    v_exp_f32 v55, v55
    v_mfma_f32_32x32x16_bf16 v[64:79], v[24:27], v[8:11], v[64:79]
    v_exp_f32 v56, v56
    v_cvt_pk_bf16_f32 v83, v54, v55
    v_exp_f32 v57, v57
    v_exp_f32 v58, v58
    v_cvt_pk_bf16_f32 v84, v56, v57
    v_exp_f32 v59, v59
    v_mfma_f32_32x32x16_bf16 v[96:111], v[28:31], v[80:83], v[96:111]
    v_exp_f32 v60, v60
    v_cvt_pk_bf16_f32 v85, v58, v59
    v_exp_f32 v61, v61
    v_exp_f32 v62, v62
    v_exp_f32 v63, v63
    v_cvt_pk_bf16_f32 v86, v60, v61
    v_cvt_pk_bf16_f32 v87, v62, v63
    s_waitcnt lgkmcnt(0)
    v_mfma_f32_32x32x8_bf16 v[48:63], v[14:15], v[12:13], 0
    v_exp_f32 v64, v64
    v_exp_f32 v65, v65
    v_exp_f32 v66, v66
    v_cvt_pk_bf16_f32 v80, v64, v65
    v_exp_f32 v67, v67
    v_mfma_f32_32x32x16_bf16 v[96:111], v[32:35], v[84:87], v[96:111]
    s_mov_b64 exec, s[74:75]
    ds_read_b128 v[28:31], v3 offset:14208
    ds_read_b128 v[32:35], v3 offset:14816
    s_mov_b64 exec, -1
    ds_read_b128 v[24:27], v1 offset:16576
    ds_read_b32 v16, v2 offset:16576
    v_exp_f32 v68, v68
    v_cvt_pk_bf16_f32 v81, v66, v67
    v_exp_f32 v69, v69
    v_exp_f32 v70, v70
    v_cvt_pk_bf16_f32 v82, v68, v69
    v_exp_f32 v71, v71
    v_mfma_f32_32x32x16_bf16 v[48:63], v[20:23], v[8:11], v[48:63]
    v_exp_f32 v72, v72
    v_cvt_pk_bf16_f32 v83, v70, v71
    v_exp_f32 v73, v73
    v_exp_f32 v74, v74
    v_cvt_pk_bf16_f32 v84, v72, v73
    v_exp_f32 v75, v75
    v_mfma_f32_32x32x16_bf16 v[96:111], v[36:39], v[80:83], v[96:111]
    v_exp_f32 v76, v76
    v_cvt_pk_bf16_f32 v85, v74, v75
    v_exp_f32 v77, v77
    v_exp_f32 v78, v78
    v_exp_f32 v79, v79
    v_cvt_pk_bf16_f32 v86, v76, v77
    v_cvt_pk_bf16_f32 v87, v78, v79
    s_waitcnt lgkmcnt(0)
    v_mfma_f32_32x32x8_bf16 v[64:79], v[16:17], v[12:13], 0
    v_exp_f32 v48, v48
    v_exp_f32 v49, v49
    v_exp_f32 v50, v50
    v_cvt_pk_bf16_f32 v80, v48, v49
    v_exp_f32 v51, v51
    v_mfma_f32_32x32x16_bf16 v[96:111], v[40:43], v[84:87], v[96:111]
    s_mov_b64 exec, s[74:75]
    ds_read_b128 v[36:39], v3 offset:16576
    ds_read_b128 v[40:43], v3 offset:17184
    s_mov_b64 exec, -1
    ds_read_b128 v[20:23], v1 offset:18944
    ds_read_b32 v14, v2 offset:18944
    v_exp_f32 v52, v52
    v_cvt_pk_bf16_f32 v81, v50, v51
    v_exp_f32 v53, v53
    v_exp_f32 v54, v54
    v_cvt_pk_bf16_f32 v82, v52, v53
    v_exp_f32 v55, v55
    v_mfma_f32_32x32x16_bf16 v[64:79], v[24:27], v[8:11], v[64:79]
    v_exp_f32 v56, v56
    v_cvt_pk_bf16_f32 v83, v54, v55
    v_exp_f32 v57, v57
    v_exp_f32 v58, v58
    v_cvt_pk_bf16_f32 v84, v56, v57
    v_exp_f32 v59, v59
    v_mfma_f32_32x32x16_bf16 v[96:111], v[28:31], v[80:83], v[96:111]
    v_exp_f32 v60, v60
    v_cvt_pk_bf16_f32 v85, v58, v59
    v_exp_f32 v61, v61
    v_exp_f32 v62, v62
    v_exp_f32 v63, v63
    v_cvt_pk_bf16_f32 v86, v60, v61
    v_cvt_pk_bf16_f32 v87, v62, v63
    s_waitcnt lgkmcnt(0)
    v_mfma_f32_32x32x8_bf16 v[48:63], v[14:15], v[12:13], 0
    v_exp_f32 v64, v64
    v_exp_f32 v65, v65
    v_exp_f32 v66, v66
    v_cvt_pk_bf16_f32 v80, v64, v65
    v_exp_f32 v67, v67
    v_mfma_f32_32x32x16_bf16 v[96:111], v[32:35], v[84:87], v[96:111]
    s_mov_b64 exec, s[74:75]
    ds_read_b128 v[28:31], v3 offset:18944
    ds_read_b128 v[32:35], v3 offset:19552
    s_mov_b64 exec, -1
    ds_read_b128 v[24:27], v1 offset:21312
    ds_read_b32 v16, v2 offset:21312
    v_exp_f32 v68, v68
    v_cvt_pk_bf16_f32 v81, v66, v67
    v_exp_f32 v69, v69
    v_exp_f32 v70, v70
    v_cvt_pk_bf16_f32 v82, v68, v69
    v_exp_f32 v71, v71
    v_mfma_f32_32x32x16_bf16 v[48:63], v[20:23], v[8:11], v[48:63]
    v_exp_f32 v72, v72
    v_cvt_pk_bf16_f32 v83, v70, v71
    v_exp_f32 v73, v73
    v_exp_f32 v74, v74
    v_cvt_pk_bf16_f32 v84, v72, v73
    v_exp_f32 v75, v75
    v_mfma_f32_32x32x16_bf16 v[96:111], v[36:39], v[80:83], v[96:111]
    v_exp_f32 v76, v76
    v_cvt_pk_bf16_f32 v85, v74, v75
    v_exp_f32 v77, v77
    v_exp_f32 v78, v78
    v_exp_f32 v79, v79
    v_cvt_pk_bf16_f32 v86, v76, v77
    v_cvt_pk_bf16_f32 v87, v78, v79
    v_add_u32 v1, 18944, v1
    v_add_u32 v2, 18944, v2
    v_add_u32 v3, 18944, v3
    s_add_u32 s71, s71, 1
    s_or_b32 s72, s70, s71
    s_cmp_lg_u32 s72, 1
    s_cbranch_scc1 L_attn_nobar1
    s_barrier
L_attn_nobar1:
    s_cmp_lg_u32 s71, 4
    s_cbranch_scc1 L_attn_pr4
    s_setprio 2
L_attn_pr4:
    s_cmp_lg_u32 s71, 6
    s_cbranch_scc1 L_attn_pr6
    s_setprio 1
L_attn_pr6:
    s_cmp_lg_u32 s71, 7
    s_cbranch_scc1 L_attn_pr7
    s_setprio 0
L_attn_pr7:
    s_cmp_lt_u32 s71, 8
    s_cbranch_scc1 L_attn_loop
    v_mfma_f32_32x32x16_bf16 v[96:111], v[40:43], v[84:87], v[96:111]
    s_waitcnt lgkmcnt(0)
    s_nop 11
    s_cmp_eq_u32 s70, 0
    s_cbranch_scc0 L_attn_fin
    v_cmp_nle_f32 vcc, 0x1f800000, v106
    s_nop 1
    s_cmp_eq_u64 vcc, 0
    s_cbranch_scc1 L_attn_fin
    s_mov_b32 s70, 256
    v_mov_b32 v13, 0
    v_mov_b32 v1, v7
    v_mov_b32 v2, v119
    v_mov_b32 v44, 0xff800000
    s_mov_b32 s71, 0
L_attn_maxloop:
    ds_read_b128 v[20:23], v1 offset:0
    ds_read_b32 v14, v2 offset:0
    v_add_u32 v1, 2368, v1
    v_add_u32 v2, 2368, v2
    s_waitcnt lgkmcnt(0)
    v_mfma_f32_32x32x8_bf16 v[48:63], v[14:15], v[12:13], 0
    v_mfma_f32_32x32x16_bf16 v[48:63], v[20:23], v[8:11], v[48:63]
    s_nop 15
    v_max3_f32 v44, v44, v48, v49
    v_max3_f32 v44, v44, v50, v51
    v_max3_f32 v44, v44, v52, v53
    v_max3_f32 v44, v44, v54, v55
    v_max3_f32 v44, v44, v56, v57
    v_max3_f32 v44, v44, v58, v59
    v_max3_f32 v44, v44, v60, v61
    v_max3_f32 v44, v44, v62, v63
    s_add_u32 s71, s71, 1
    s_cmp_lt_u32 s71, 64
    s_cbranch_scc1 L_attn_maxloop
    v_mov_b32 v45, v44
    s_nop 1
    v_permlane32_swap_b32 v44, v45
    v_max_f32 v44, v44, v45
    v_sub_f32 v44, 0, v44
    v_mov_b32 v96, 0
    v_mov_b32 v97, 0
    v_mov_b32 v98, 0
    v_mov_b32 v99, 0
    v_mov_b32 v100, 0
    v_mov_b32 v101, 0
    v_mov_b32 v102, 0
    v_mov_b32 v103, 0
    v_mov_b32 v104, 0
    v_mov_b32 v105, 0
    v_mov_b32 v106, 0
    v_mov_b32 v107, 0
    v_mov_b32 v108, 0
    v_mov_b32 v109, 0
    v_mov_b32 v110, 0
    v_mov_b32 v111, 0
    v_mov_b32 v84, 0
    v_mov_b32 v85, 0
    v_mov_b32 v86, 0
    v_mov_b32 v87, 0
    v_mov_b32 v28, 0
    v_mov_b32 v29, 0
    v_mov_b32 v30, 0
    v_mov_b32 v31, 0
    v_mov_b32 v32, 0
    v_mov_b32 v33, 0
    v_mov_b32 v34, 0
    v_mov_b32 v35, 0
    v_mov_b32 v36, 0
    v_mov_b32 v37, 0
    v_mov_b32 v38, 0
    v_mov_b32 v39, 0
    v_mov_b32 v40, 0
    v_mov_b32 v41, 0
    v_mov_b32 v42, 0
    v_mov_b32 v43, 0
    v_mov_b32 v1, v7
    v_mov_b32 v2, v119
    v_mov_b32 v3, v120
    ds_read_b128 v[20:23], v1 offset:0
    ds_read_b32 v14, v2 offset:0
    ds_read_b128 v[24:27], v1 offset:2368
    ds_read_b32 v16, v2 offset:2368
    s_mov_b64 exec, s[74:75]
    ds_read_b128 v[28:31], v3 offset:0
    ds_read_b128 v[32:35], v3 offset:608
    s_mov_b64 exec, -1
    s_branch L_attn_setshift
L_attn_fin:
    v_rcp_f32 v44, v106
    s_mul_i32 s47, s45, 36864
    s_add_u32 s47, s47, 2752512
    s_lshr_b32 s48, s40, 1
    s_lshl_b32 s48, s48, 11
    s_and_b32 s49, s40, 1
    s_lshl_b32 s49, s49, 9
    s_add_u32 s48, s48, s49
    s_add_u32 s48, s48, s47
    v_and_b32 v45, 15, v18
    v_bfe_u32 v46, v18, 4, 1
    v_lshlrev_b32 v45, 4, v45
    v_lshl_add_u32 v45, v46, 10, v45
    v_lshl_add_u32 v46, v4, 8, v45
    v_mul_f32 v96, v96, v44
    v_mul_f32 v97, v97, v44
    v_mul_f32 v98, v98, v44
    v_mul_f32 v99, v99, v44
    v_mul_f32 v100, v100, v44
    v_mul_f32 v101, v101, v44
    v_mul_f32 v102, v102, v44
    v_mul_f32 v103, v103, v44
    v_mul_f32 v104, v104, v44
    v_mul_f32 v105, v105, v44
    v_cvt_pk_bf16_f32 v80, v96, v97
    v_cvt_pk_bf16_f32 v81, v98, v99
    v_cvt_pk_bf16_f32 v82, v100, v101
    v_cvt_pk_bf16_f32 v83, v102, v103
    v_cvt_pk_bf16_f32 v84, v104, v105
    buffer_store_dwordx4 v[80:83], v46, s[24:27], s48 offen sc1
    s_lshr_b32 s48, s40, 4
    s_lshl_b32 s48, s48, 11
    s_add_u32 s48, s48, s47
    s_add_u32 s48, s48, 32768
    s_bfe_u32 s49, s40, 0x20002
    s_lshl_b32 s49, s49, 8
    s_add_u32 s48, s48, s49
    s_and_b32 s49, s40, 3
    s_lshl_b32 s49, s49, 2
    s_add_u32 s48, s48, s49
    s_mov_b32 exec_hi, 0
    buffer_store_dword v84, v45, s[24:27], s48 offen sc1
    s_mov_b64 exec, -1
L_attn_end:
    s_endpgm
L_attn_prod:
    s_cmp_lt_u32 s39, 2
    s_cbranch_scc1 L_attn_prod2
    buffer_load_dword v16, v64, s[4:7], 0 offen offset:128 sc1
    s_load_dwordx2 s[64:65], s[0:1], 32
    s_load_dwordx4 s[68:71], s[0:1], 48
    s_load_dwordx4 s[72:75], s[0:1], 64
    s_load_dwordx2 s[76:77], s[0:1], 80
    v_lshlrev_b32 v19, 20, v18
    buffer_load_dword v16, v19, s[24:27], 0 offen
    v_min_u32 v17, 0x500000, v19
    v_min_u32 v19, 0x200000, v19
    s_waitcnt lgkmcnt(0)
    global_load_dword v16, v64, s[64:65]
    global_load_dword v16, v17, s[68:69]
    global_load_dword v16, v64, s[70:71]
    global_load_dword v16, v17, s[72:73]
    global_load_dword v16, v64, s[74:75]
    global_load_dword v16, v19, s[76:77]
    s_branch L_attn_aux
L_attn_prod2:
    s_cmp_gt_u32 s39, 1
    s_cbranch_scc1 L_attn_aux
    s_setprio 3
    s_cmp_eq_u32 s39, 1
    s_cselect_b32 s20, s58, s56
    s_cselect_b32 s21, s59, s57
    s_mov_b32 s22, 20736
    s_mov_b32 s23, 0x00020000
    s_movk_i32 s49, 21846
    v_add_u32 v44, 0, v18
    v_mul_lo_u32 v45, v44, s49
    v_lshrrev_b32 v45, 16, v45
    v_mul_u32_u24 v45, 12, v45
    v_lshlrev_b32 v44, 4, v44
    v_sub_u32 v8, v44, v45
    v_add_u32 v44, 64, v18
    v_mul_lo_u32 v45, v44, s49
    v_lshrrev_b32 v45, 16, v45
    v_mul_u32_u24 v45, 12, v45
    v_lshlrev_b32 v44, 4, v44
    v_sub_u32 v9, v44, v45
    v_add_u32 v44, 128, v18
    v_mul_lo_u32 v45, v44, s49
    v_lshrrev_b32 v45, 16, v45
    v_mul_u32_u24 v45, 12, v45
    v_lshlrev_b32 v44, 4, v44
    v_sub_u32 v10, v44, v45
    s_mul_i32 s43, s45, 2368
    s_add_u32 s43, s43, 2359296
    s_sub_u32 s42, s38, 9
    s_mul_i32 s50, s42, 9216
    s_mul_i32 s51, s42, 12288
    s_add_u32 m0, s51, 0
    s_nop 0
    buffer_load_dwordx4 v8, s[20:23], s50 offen lds
    s_add_u32 m0, s51, 1024
    s_nop 0
    buffer_load_dwordx4 v9, s[20:23], s50 offen lds
    s_add_u32 m0, s51, 2048
    s_nop 0
    buffer_load_dwordx4 v10, s[20:23], s50 offen lds
    s_add_u32 s50, s50, 2304
    s_add_u32 m0, s51, 3072
    s_nop 0
    buffer_load_dwordx4 v8, s[20:23], s50 offen lds
    s_add_u32 m0, s51, 4096
    s_nop 0
    buffer_load_dwordx4 v9, s[20:23], s50 offen lds
    s_add_u32 m0, s51, 5120
    s_nop 0
    buffer_load_dwordx4 v10, s[20:23], s50 offen lds
    s_add_u32 s50, s50, 2304
    s_add_u32 m0, s51, 6144
    s_nop 0
    buffer_load_dwordx4 v8, s[20:23], s50 offen lds
    s_add_u32 m0, s51, 7168
    s_nop 0
    buffer_load_dwordx4 v9, s[20:23], s50 offen lds
    s_add_u32 m0, s51, 8192
    s_nop 0
    buffer_load_dwordx4 v10, s[20:23], s50 offen lds
    s_add_u32 s50, s50, 2304
    s_add_u32 m0, s51, 9216
    s_nop 0
    buffer_load_dwordx4 v8, s[20:23], s50 offen lds
    s_add_u32 m0, s51, 10240
    s_nop 0
    buffer_load_dwordx4 v9, s[20:23], s50 offen lds
    s_add_u32 m0, s51, 11264
    s_nop 0
    buffer_load_dwordx4 v10, s[20:23], s50 offen lds
    s_add_u32 s50, s50, 2304
    s_add_u32 m0, s51, 12288
    s_nop 0
    buffer_load_dwordx4 v8, s[20:23], s50 offen lds
    s_add_u32 m0, s51, 13312
    s_nop 0
    buffer_load_dwordx4 v9, s[20:23], s50 offen lds
    s_add_u32 m0, s51, 14336
    s_nop 0
    buffer_load_dwordx4 v10, s[20:23], s50 offen lds
    s_add_u32 s50, s50, 2304
    s_setprio 0
    v_lshlrev_b32 v19, 20, v18
    v_min_u32 v19, 0x500000, v19
    buffer_load_dword v16, v19, s[24:27], 0 offen
    buffer_load_dword v16, v64, s[4:7], 0 offen offset:128 sc1
    s_mul_i32 s49, s42, 18432
    v_add_u32 v45, 0, v4
    v_xor_b32 v46, v45, v3
    v_lshlrev_b32 v45, 9, v45
    v_lshl_add_u32 v112, v46, 4, v45
    v_add_u32 v112, s49, v112
    v_add_u32 v45, 2, v4
    v_xor_b32 v46, v45, v3
    v_lshlrev_b32 v45, 9, v45
    v_lshl_add_u32 v113, v46, 4, v45
    v_add_u32 v113, s49, v113
    v_add_u32 v45, 4, v4
    v_xor_b32 v46, v45, v3
    v_lshlrev_b32 v45, 9, v45
    v_lshl_add_u32 v114, v46, 4, v45
    v_add_u32 v114, s49, v114
    v_add_u32 v45, 6, v4
    v_xor_b32 v46, v45, v3
    v_lshlrev_b32 v45, 9, v45
    v_lshl_add_u32 v115, v46, 4, v45
    v_add_u32 v115, s49, v115
    v_add_u32 v45, 8, v4
    v_xor_b32 v46, v45, v3
    v_lshlrev_b32 v45, 9, v45
    v_lshl_add_u32 v116, v46, 4, v45
    v_add_u32 v116, s49, v116
    v_add_u32 v45, 10, v4
    v_xor_b32 v46, v45, v3
    v_lshlrev_b32 v45, 9, v45
    v_lshl_add_u32 v117, v46, 4, v45
    v_add_u32 v117, s49, v117
    v_bfe_u32 v45, v18, 2, 2
    v_lshl_add_u32 v45, v4, 3, v45
    v_bfe_u32 v46, v18, 4, 1
    v_and_b32 v47, 3, v18
    v_lshlrev_b32 v47, 3, v47
    v_lshl_add_u32 v46, v46, 5, v47
    v_mul_u32_u24 v118, 48, v45
    s_mul_i32 s49, s42, 13824
    v_add3_u32 v118, v118, v46, s49
    v_cmp_eq_u32 vcc, 22, v3
    v_mov_b32 v1, 18
    v_mul_u32_u24 v44, 19, v4
    v_cndmask_b32 v45, v3, v1, vcc
    v_add_u32 v45, v45, v44
    v_lshlrev_b32 v45, 4, v45
    v_add_u32 v120, 1152, v45
    v_cmp_eq_u32 vcc, 0, v4
    s_mov_b32 s74, 0x47ffff
    s_mov_b32 s75, 0x47ffff
    s_mov_b64 s[60:61], vcc
    v_mov_b32 v121, 163792
    v_add_u32 v122, 159744, v7
    s_waitcnt vmcnt(2)
    ds_read_b64_tr_b16 v[24:25], v118 offset:0
    ds_read_b64_tr_b16 v[26:27], v118 offset:192
    ds_read_b64_tr_b16 v[28:29], v118 offset:768
    ds_read_b64_tr_b16 v[30:31], v118 offset:960
    ds_read_b64_tr_b16 v[32:33], v118 offset:1536
    ds_read_b64_tr_b16 v[34:35], v118 offset:1728
    ds_read_b64_tr_b16 v[36:37], v118 offset:2304
    ds_read_b64_tr_b16 v[38:39], v118 offset:2496
    ds_read_b64_tr_b16 v[40:41], v118 offset:3072
    ds_read_b64_tr_b16 v[42:43], v118 offset:3264
    ds_read_b64_tr_b16 v[44:45], v118 offset:3840
    ds_read_b64_tr_b16 v[46:47], v118 offset:4032
    ds_read_b64_tr_b16 v[48:49], v118 offset:4608
    ds_read_b64_tr_b16 v[50:51], v118 offset:4800
    ds_read_b64_tr_b16 v[52:53], v118 offset:5376
    ds_read_b64_tr_b16 v[54:55], v118 offset:5568
    ds_read_b64_tr_b16 v[56:57], v118 offset:6144
    ds_read_b64_tr_b16 v[58:59], v118 offset:6336
    ds_read_b64_tr_b16 v[60:61], v118 offset:6912
    ds_read_b64_tr_b16 v[62:63], v118 offset:7104
    ds_read_b64_tr_b16 v[64:65], v118 offset:7680
    ds_read_b64_tr_b16 v[66:67], v118 offset:7872
    ds_read_b64_tr_b16 v[68:69], v118 offset:8448
    ds_read_b64_tr_b16 v[70:71], v118 offset:8640
    ds_read_b64_tr_b16 v[72:73], v118 offset:9216
    ds_read_b64_tr_b16 v[74:75], v118 offset:9408
    ds_read_b64_tr_b16 v[76:77], v118 offset:9984
    ds_read_b64_tr_b16 v[78:79], v118 offset:10176
    ds_read_b64_tr_b16 v[80:81], v118 offset:10752
    ds_read_b64_tr_b16 v[82:83], v118 offset:10944
    ds_read_b64_tr_b16 v[84:85], v118 offset:11520
    ds_read_b64_tr_b16 v[86:87], v118 offset:11712
    ds_read_b64_tr_b16 v[88:89], v118 offset:12288
    ds_read_b64_tr_b16 v[90:91], v118 offset:12480
    ds_read_b64_tr_b16 v[92:93], v118 offset:13056
    ds_read_b64_tr_b16 v[94:95], v118 offset:13248
    v_mov_b32 v19, 1
    s_waitcnt lgkmcnt(0)
    s_mov_b64 exec, 1
    ds_add_u32 v121, v19 offset:20
    s_mov_b64 exec, -1
L_attn_pxn:
    ds_read_b32 v19, v121 offset:12
    s_waitcnt lgkmcnt(0)
    v_readfirstlane_b32 s49, v19
    s_nop 0
    s_cmp_ge_u32 s49, 8
    s_cbranch_scc1 L_attn_pxnx
    s_sleep 1
    s_branch L_attn_pxn
L_attn_pxnx:
    s_setprio 3
    s_cmp_eq_u32 s39, 1
    s_cbranch_scc1 L_attn_gv
    ds_read_b128 v[8:11], v112 offset:27648
    ds_read_b128 v[12:15], v113 offset:27648
    ds_read_b128 v[20:23], v114 offset:27648
    ds_read_b128 v[124:127], v115 offset:27648
    s_waitcnt lgkmcnt(3)
    v_mfma_f32_32x32x16_bf16 v[96:111], v[24:27], v[8:11], 0
    ds_read_b128 v[8:11], v116 offset:27648
    s_waitcnt lgkmcnt(3)
    v_mfma_f32_32x32x16_bf16 v[96:111], v[28:31], v[12:15], v[96:111]
    ds_read_b128 v[12:15], v117 offset:27648
    s_waitcnt lgkmcnt(3)
    v_mfma_f32_32x32x16_bf16 v[96:111], v[32:35], v[20:23], v[96:111]
    ds_read_b128 v[20:23], v112 offset:33792
    s_waitcnt lgkmcnt(3)
    v_mfma_f32_32x32x16_bf16 v[96:111], v[36:39], v[124:127], v[96:111]
    ds_read_b128 v[124:127], v113 offset:33792
    s_waitcnt lgkmcnt(3)
    v_mfma_f32_32x32x16_bf16 v[96:111], v[40:43], v[8:11], v[96:111]
    ds_read_b128 v[8:11], v114 offset:33792
    s_waitcnt lgkmcnt(3)
    v_mfma_f32_32x32x16_bf16 v[96:111], v[44:47], v[12:15], v[96:111]
    ds_read_b128 v[12:15], v115 offset:33792
    s_waitcnt lgkmcnt(3)
    v_mfma_f32_32x32x16_bf16 v[96:111], v[48:51], v[20:23], v[96:111]
    ds_read_b128 v[20:23], v116 offset:33792
    s_waitcnt lgkmcnt(3)
    v_mfma_f32_32x32x16_bf16 v[96:111], v[52:55], v[124:127], v[96:111]
    ds_read_b128 v[124:127], v117 offset:33792
    s_waitcnt lgkmcnt(3)
    v_mfma_f32_32x32x16_bf16 v[96:111], v[56:59], v[8:11], v[96:111]
    ds_read_b128 v[8:11], v112 offset:39936
    s_waitcnt lgkmcnt(3)
    v_mfma_f32_32x32x16_bf16 v[96:111], v[60:63], v[12:15], v[96:111]
    ds_read_b128 v[12:15], v113 offset:39936
    s_waitcnt lgkmcnt(3)
    v_mfma_f32_32x32x16_bf16 v[96:111], v[64:67], v[20:23], v[96:111]
    ds_read_b128 v[20:23], v114 offset:39936
    s_waitcnt lgkmcnt(3)
    v_mfma_f32_32x32x16_bf16 v[96:111], v[68:71], v[124:127], v[96:111]
    ds_read_b128 v[124:127], v115 offset:39936
    s_waitcnt lgkmcnt(3)
    v_mfma_f32_32x32x16_bf16 v[96:111], v[72:75], v[8:11], v[96:111]
    ds_read_b128 v[8:11], v116 offset:39936
    s_waitcnt lgkmcnt(3)
    v_mfma_f32_32x32x16_bf16 v[96:111], v[76:79], v[12:15], v[96:111]
    ds_read_b128 v[12:15], v117 offset:39936
    s_waitcnt lgkmcnt(3)
    v_mfma_f32_32x32x16_bf16 v[96:111], v[80:83], v[20:23], v[96:111]
    s_waitcnt lgkmcnt(2)
    v_mfma_f32_32x32x16_bf16 v[96:111], v[84:87], v[124:127], v[96:111]
    s_waitcnt lgkmcnt(1)
    v_mfma_f32_32x32x16_bf16 v[96:111], v[88:91], v[8:11], v[96:111]
    s_waitcnt lgkmcnt(0)
    v_mfma_f32_32x32x16_bf16 v[96:111], v[92:95], v[12:15], v[96:111]
    s_branch L_attn_gd
L_attn_gv:
    ds_read_b128 v[8:11], v112 offset:27648
    ds_read_b128 v[12:15], v113 offset:27648
    ds_read_b128 v[20:23], v114 offset:27648
    ds_read_b128 v[124:127], v115 offset:27648
    s_waitcnt lgkmcnt(3)
    v_mfma_f32_32x32x16_bf16 v[96:111], v[8:11], v[24:27], 0
    ds_read_b128 v[8:11], v116 offset:27648
    s_waitcnt lgkmcnt(3)
    v_mfma_f32_32x32x16_bf16 v[96:111], v[12:15], v[28:31], v[96:111]
    ds_read_b128 v[12:15], v117 offset:27648
    s_waitcnt lgkmcnt(3)
    v_mfma_f32_32x32x16_bf16 v[96:111], v[20:23], v[32:35], v[96:111]
    ds_read_b128 v[20:23], v112 offset:33792
    s_waitcnt lgkmcnt(3)
    v_mfma_f32_32x32x16_bf16 v[96:111], v[124:127], v[36:39], v[96:111]
    ds_read_b128 v[124:127], v113 offset:33792
    s_waitcnt lgkmcnt(3)
    v_mfma_f32_32x32x16_bf16 v[96:111], v[8:11], v[40:43], v[96:111]
    ds_read_b128 v[8:11], v114 offset:33792
    s_waitcnt lgkmcnt(3)
    v_mfma_f32_32x32x16_bf16 v[96:111], v[12:15], v[44:47], v[96:111]
    ds_read_b128 v[12:15], v115 offset:33792
    s_waitcnt lgkmcnt(3)
    v_mfma_f32_32x32x16_bf16 v[96:111], v[20:23], v[48:51], v[96:111]
    ds_read_b128 v[20:23], v116 offset:33792
    s_waitcnt lgkmcnt(3)
    v_mfma_f32_32x32x16_bf16 v[96:111], v[124:127], v[52:55], v[96:111]
    ds_read_b128 v[124:127], v117 offset:33792
    s_waitcnt lgkmcnt(3)
    v_mfma_f32_32x32x16_bf16 v[96:111], v[8:11], v[56:59], v[96:111]
    ds_read_b128 v[8:11], v112 offset:39936
    s_waitcnt lgkmcnt(3)
    v_mfma_f32_32x32x16_bf16 v[96:111], v[12:15], v[60:63], v[96:111]
    ds_read_b128 v[12:15], v113 offset:39936
    s_waitcnt lgkmcnt(3)
    v_mfma_f32_32x32x16_bf16 v[96:111], v[20:23], v[64:67], v[96:111]
    ds_read_b128 v[20:23], v114 offset:39936
    s_waitcnt lgkmcnt(3)
    v_mfma_f32_32x32x16_bf16 v[96:111], v[124:127], v[68:71], v[96:111]
    ds_read_b128 v[124:127], v115 offset:39936
    s_waitcnt lgkmcnt(3)
    v_mfma_f32_32x32x16_bf16 v[96:111], v[8:11], v[72:75], v[96:111]
    ds_read_b128 v[8:11], v116 offset:39936
    s_waitcnt lgkmcnt(3)
    v_mfma_f32_32x32x16_bf16 v[96:111], v[12:15], v[76:79], v[96:111]
    ds_read_b128 v[12:15], v117 offset:39936
    s_waitcnt lgkmcnt(3)
    v_mfma_f32_32x32x16_bf16 v[96:111], v[20:23], v[80:83], v[96:111]
    s_waitcnt lgkmcnt(2)
    v_mfma_f32_32x32x16_bf16 v[96:111], v[124:127], v[84:87], v[96:111]
    s_waitcnt lgkmcnt(1)
    v_mfma_f32_32x32x16_bf16 v[96:111], v[8:11], v[88:91], v[96:111]
    s_waitcnt lgkmcnt(0)
    v_mfma_f32_32x32x16_bf16 v[96:111], v[12:15], v[92:95], v[96:111]
L_attn_gd:
    v_mov_b32 v19, 1
    s_nop 11
    s_cmp_eq_u32 s42, 0
    s_cbranch_scc1 L_attn_comb
    ds_write_b128 v122, v[96:99] offset:0
    ds_write_b128 v122, v[100:103] offset:1024
    ds_write_b128 v122, v[104:107] offset:2048
    s_mov_b32 exec_hi, 0x3ffff
    ds_write_b128 v122, v[108:111] offset:3072
    ds_write_b32 v121, v19 offset:16
    s_waitcnt lgkmcnt(0)
    s_mov_b64 exec, -1
    s_branch L_attn_aux
L_attn_comb:
    ds_read_b32 v19, v121 offset:16
    ds_read_b128 v[64:67], v122 offset:0
    ds_read_b128 v[68:71], v122 offset:1024
    ds_read_b128 v[72:75], v122 offset:2048
    ds_read_b128 v[76:79], v122 offset:3072
    s_waitcnt lgkmcnt(0)
    v_readfirstlane_b32 s49, v19
    s_nop 0
    s_cmp_eq_u32 s49, 0
    s_cbranch_scc1 L_attn_comb
    v_add_f32 v96, v96, v64
    v_add_f32 v97, v97, v65
    v_add_f32 v98, v98, v66
    v_add_f32 v99, v99, v67
    v_add_f32 v100, v100, v68
    v_add_f32 v101, v101, v69
    v_add_f32 v102, v102, v70
    v_add_f32 v103, v103, v71
    v_add_f32 v104, v104, v72
    v_add_f32 v105, v105, v73
    v_add_f32 v106, v106, v74
    v_add_f32 v107, v107, v75
    v_add_f32 v108, v108, v76
    v_add_f32 v109, v109, v77
    v_add_f32 v110, v110, v78
    v_add_f32 v111, v111, v79
    s_cmp_eq_u32 s39, 1
    s_cbranch_scc1 L_attn_mkv
    v_cvt_pk_bf16_f32 v48, v96, v97
    v_cvt_pk_bf16_f32 v49, v98, v99
    v_cvt_pk_bf16_f32 v50, v100, v101
    v_cvt_pk_bf16_f32 v51, v102, v103
    v_cvt_pk_bf16_f32 v52, v104, v105
    v_mov_b32 v44, 0
    v_lshlrev_b32 v45, 2, v3
    v_cndmask_b32 v53, v44, v52, s[60:61]
    v_dot2c_f32_bf16 v44, v48, v48
    v_dot2c_f32_bf16 v44, v49, v49
    v_dot2c_f32_bf16 v44, v50, v50
    v_dot2c_f32_bf16 v44, v51, v51
    v_dot2c_f32_bf16 v44, v53, v53
    v_permlane32_swap_b32 v48, v50
    v_permlane32_swap_b32 v49, v51
    s_nop 0
    v_mov_b32 v46, v44
    buffer_store_dwordx4 v[48:51], v7, s[24:27], s43 offen sc1
    s_mov_b32 exec_hi, 0
    buffer_store_dword v52, v45, s[24:27], s43 offen offset:1024 sc1
    s_mov_b64 exec, -1
    v_permlane32_swap_b32 v44, v46
    v_add_f32 v44, v44, v46
    s_nop 1
    v_max_f32_dpp v44, v44, v44 row_ror:1 row_mask:0xf bank_mask:0xf
    s_nop 1
    v_max_f32_dpp v44, v44, v44 row_ror:2 row_mask:0xf bank_mask:0xf
    s_nop 1
    v_max_f32_dpp v44, v44, v44 row_ror:4 row_mask:0xf bank_mask:0xf
    s_nop 1
    v_max_f32_dpp v44, v44, v44 row_ror:8 row_mask:0xf bank_mask:0xf
    s_nop 0
    v_readlane_b32 s64, v44, 0
    v_readlane_b32 s65, v44, 16
    s_nop 1
    s_max_u32 s64, s64, s65
    s_lshl_b32 s65, s45, 7
    s_add_u32 s65, s65, 2515968
    v_mov_b32 v44, s64
    v_mov_b32 v45, 0
    s_mov_b64 exec, 1
    buffer_store_dword v44, v45, s[24:27], s65 offen sc1
    s_mov_b64 exec, -1
    s_branch L_attn_flag
L_attn_mkv:
    v_cmp_eq_u32 vcc, 18, v3
    v_mov_b32 v44, 0x3f803f80
    v_cvt_pk_bf16_f32 v48, v96, v97
    v_cvt_pk_bf16_f32 v49, v98, v99
    v_cvt_pk_bf16_f32 v50, v100, v101
    v_cvt_pk_bf16_f32 v51, v102, v103
    v_cvt_pk_bf16_f32 v52, v104, v105
    v_cvt_pk_bf16_f32 v53, v106, v107
    v_cvt_pk_bf16_f32 v54, v108, v109
    v_cvt_pk_bf16_f32 v55, v110, v111
    v_cndmask_b32 v48, v48, v44, vcc
    v_cndmask_b32 v49, v49, v44, vcc
    v_cndmask_b32 v50, v50, v44, vcc
    v_cndmask_b32 v51, v51, v44, vcc
    v_cndmask_b32 v52, v52, v44, vcc
    v_cndmask_b32 v53, v53, v44, vcc
    v_cndmask_b32 v54, v54, v44, vcc
    v_cndmask_b32 v55, v55, v44, vcc
    s_mov_b32 exec_lo, 0x7ffff
    s_mov_b32 exec_hi, 0x7ffff
    buffer_store_dwordx4 v[48:51], v120, s[24:27], s43 offen sc1
    buffer_store_dwordx4 v[52:55], v120, s[24:27], s43 offen offset:608 sc1
    s_mov_b64 exec, -1
L_attn_flag:
    v_mov_b32 v46, 1
    v_mov_b32 v45, 0
    s_mov_b64 exec, 1
    s_waitcnt vmcnt(0)
    buffer_atomic_add v46, v45, s[4:7], 0 offen sc0
    s_waitcnt vmcnt(0) lgkmcnt(0)
    v_readfirstlane_b32 s64, v46
    v_mov_b32 v46, 1
    s_cmp_eq_u32 s64, 127
    s_cbranch_scc0 L_attn_notlast
    buffer_store_dword v46, v45, s[4:7], 0 offen offset:128 sc1
L_attn_notlast:
    s_mov_b64 exec, -1
L_attn_aux:
    s_setprio 0
    s_add_u32 s8, s30, 2359296
    s_addc_u32 s9, s31, 0
    s_mov_b32 s10, 151552
    s_mov_b32 s11, 0x00020000
    s_sub_u32 s42, s38, 8
    s_mul_i32 s50, s42, 40960
    s_add_u32 s50, s50, 28672
    v_mov_b32 v112, -1
    v_mov_b32 v113, -1
    v_mov_b32 v114, -1
    v_mov_b32 v115, -1
    s_mul_i32 s74, s34, 2359296
    s_mul_i32 s75, s35, 73728
    s_add_u32 s74, s74, s75
    s_add_u32 s74, s74, 7471104
    s_lshl_b32 s76, s34, 13
    s_add_u32 s76, s76, s75
    s_add_u32 s76, s76, 5111808
    s_add_u32 s77, s34, 5
    s_and_b32 s77, s77, 7
    s_lshl_b32 s77, s77, 13
    s_add_u32 s77, s77, s74
    s_cmp_eq_u32 s42, 2
    s_cselect_b32 s76, s77, s76
    s_sub_u32 s77, s34, s42
    s_and_b32 s77, s77, 7
    s_lshl_b32 s77, s77, 13
    s_add_u32 s77, s77, s74
    s_load_dwordx2 s[68:69], s[0:1], 48
    s_mul_i32 s65, s2, 911
    s_lshr_b32 s65, s65, 16
    s_mul_i32 s66, s65, 72
    s_sub_u32 s66, s2, s66
    s_mul_i32 s67, s65, 1769472
    s_lshl_b32 s70, s66, 7
    s_add_u32 s67, s67, s70
    s_mul_i32 s71, s65, 18432
    s_lshl_b32 s70, s66, 8
    s_add_u32 s71, s71, s70
    s_waitcnt vmcnt(0) lgkmcnt(0)
    s_mov_b32 s20, s68
    s_mov_b32 s21, s69
    s_mov_b32 s22, 5308416
    s_mov_b32 s23, 0x00020000
    v_lshrrev_b32 v20, 3, v18
    v_mul_u32_u24 v20, 9216, v20
    v_and_b32 v21, 7, v18
    v_lshl_add_u32 v20, v21, 4, v20
    v_lshlrev_b32 v21, 5, v21
    v_and_b32 v22, 16, v18
    v_add_u32 v21, v21, v22
    v_and_b32 v22, 15, v18
    v_mov_b32 v16, 0x3f80
    v_mov_b32 v17, 0x3f800000
    v_mov_b32 v19, 0
    v_cmp_eq_u32 vcc, 0, v22
    v_cmp_eq_u32 s[72:73], 1, v22
    s_nop 0
    v_cndmask_b32 v8, v19, v16, vcc
    v_cndmask_b32 v8, v8, v17, s[72:73]
    v_cmp_eq_u32 vcc, 2, v22
    v_cmp_eq_u32 s[72:73], 3, v22
    s_nop 0
    v_cndmask_b32 v9, v19, v16, vcc
    v_cndmask_b32 v9, v9, v17, s[72:73]
    v_cmp_eq_u32 vcc, 4, v22
    v_cmp_eq_u32 s[72:73], 5, v22
    s_nop 0
    v_cndmask_b32 v10, v19, v16, vcc
    v_cndmask_b32 v10, v10, v17, s[72:73]
    v_cmp_eq_u32 vcc, 6, v22
    v_cmp_eq_u32 s[72:73], 7, v22
    s_nop 0
    v_cndmask_b32 v11, v19, v16, vcc
    v_cndmask_b32 v11, v11, v17, s[72:73]
    s_barrier
    s_mov_b32 m0, s50
    s_nop 0
    buffer_load_dwordx4 v7, s[8:11], s50 offen offset:0 sc1 lds
    buffer_load_dwordx4 v7, s[8:11], s50 offen offset:1024 sc1 lds
    buffer_load_dwordx4 v7, s[8:11], s50 offen offset:2048 sc1 lds
    buffer_load_dwordx4 v7, s[8:11], s50 offen offset:3072 sc1 lds
    s_add_u32 s50, s50, 4096
    s_mov_b32 m0, s50
    s_nop 0
    buffer_load_dwordx4 v7, s[8:11], s50 offen offset:0 sc1 lds
    buffer_load_dwordx4 v7, s[8:11], s50 offen offset:1024 sc1 lds
    buffer_load_dwordx4 v7, s[8:11], s50 offen offset:2048 sc1 lds
    buffer_load_dwordx4 v7, s[8:11], s50 offen offset:3072 sc1 lds
    s_add_u32 s50, s50, 4096
    s_mov_b32 m0, s50
    s_nop 0
    buffer_load_dwordx4 v7, s[8:11], s50 offen offset:0 sc1 lds
    buffer_load_dwordx4 v7, s[8:11], s50 offen offset:1024 sc1 lds
    buffer_load_dwordx4 v7, s[8:11], s50 offen offset:2048 sc1 lds
    buffer_load_dwordx4 v7, s[8:11], s50 offen offset:3072 sc1 lds
    s_add_u32 s50, s50, 4096
    s_mov_b32 m0, s50
    s_nop 0
    buffer_load_dwordx4 v7, s[8:11], s50 offen offset:0 sc1 lds
    buffer_load_dwordx4 v7, s[8:11], s50 offen offset:1024 sc1 lds
    buffer_load_dwordx4 v7, s[8:11], s50 offen offset:2048 sc1 lds
    buffer_load_dwordx4 v7, s[8:11], s50 offen offset:3072 sc1 lds
    s_add_u32 s50, s50, 4096
    s_mov_b32 m0, s50
    s_nop 0
    buffer_load_dwordx4 v7, s[8:11], s50 offen offset:0 sc1 lds
    buffer_load_dwordx4 v7, s[8:11], s50 offen offset:1024 sc1 lds
    buffer_load_dwordx4 v7, s[8:11], s50 offen offset:2048 sc1 lds
    buffer_load_dwordx4 v7, s[8:11], s50 offen offset:3072 sc1 lds
    s_add_u32 s50, s50, 4096
    s_mov_b32 m0, s50
    s_nop 0
    buffer_load_dwordx4 v7, s[8:11], s50 offen offset:0 sc1 lds
    buffer_load_dwordx4 v7, s[8:11], s50 offen offset:1024 sc1 lds
    buffer_load_dwordx4 v7, s[8:11], s50 offen offset:2048 sc1 lds
    buffer_load_dwordx4 v7, s[8:11], s50 offen offset:3072 sc1 lds
    s_add_u32 s50, s50, 4096
    s_mov_b32 m0, s50
    s_nop 0
    buffer_load_dwordx4 v7, s[8:11], s50 offen offset:0 sc1 lds
    buffer_load_dwordx4 v7, s[8:11], s50 offen offset:1024 sc1 lds
    buffer_load_dwordx4 v7, s[8:11], s50 offen offset:2048 sc1 lds
    buffer_load_dwordx4 v7, s[8:11], s50 offen offset:3072 sc1 lds
    s_add_u32 s50, s50, 4096
    s_mov_b32 m0, s50
    s_nop 0
    buffer_load_dwordx4 v7, s[8:11], s50 offen offset:0 sc1 lds
    buffer_load_dwordx4 v7, s[8:11], s50 offen offset:1024 sc1 lds
    buffer_load_dwordx4 v7, s[8:11], s50 offen offset:2048 sc1 lds
    buffer_load_dwordx4 v7, s[8:11], s50 offen offset:3072 sc1 lds
    s_add_u32 s50, s50, 4096
    s_mov_b32 m0, s50
    s_nop 0
    buffer_load_dwordx4 v7, s[8:11], s50 offen offset:0 sc1 lds
    buffer_load_dwordx4 v7, s[8:11], s50 offen offset:1024 sc1 lds
    buffer_load_dwordx4 v7, s[8:11], s50 offen offset:2048 sc1 lds
    buffer_load_dwordx4 v7, s[8:11], s50 offen offset:3072 sc1 lds
    s_add_u32 s50, s50, 4096
    s_mov_b32 m0, s50
    s_nop 0
    buffer_load_dwordx4 v7, s[8:11], s50 offen offset:0 sc1 lds
    buffer_load_dwordx4 v7, s[8:11], s50 offen offset:1024 sc1 lds
    buffer_load_dwordx4 v7, s[8:11], s50 offen offset:2048 sc1 lds
    buffer_load_dwordx4 v7, s[8:11], s50 offen offset:3072 sc1 lds
    s_add_u32 s50, s50, 4096
    s_waitcnt vmcnt(0)
    s_barrier
    s_add_u32 s78, s76, 4096
    buffer_store_dwordx4 v[112:115], v7, s[24:27], s76 offen offset:0 sc1
    buffer_store_dwordx4 v[112:115], v7, s[24:27], s78 offen offset:0 sc1
    buffer_store_dwordx4 v[112:115], v7, s[24:27], s76 offen offset:1024 sc1
    buffer_store_dwordx4 v[112:115], v7, s[24:27], s78 offen offset:1024 sc1
    buffer_store_dwordx4 v[112:115], v7, s[24:27], s76 offen offset:2048 sc1
    buffer_store_dwordx4 v[112:115], v7, s[24:27], s78 offen offset:2048 sc1
    buffer_store_dwordx4 v[112:115], v7, s[24:27], s76 offen offset:3072 sc1
    buffer_store_dwordx4 v[112:115], v7, s[24:27], s78 offen offset:3072 sc1
    s_add_u32 s78, s77, 4096
    buffer_store_dwordx4 v[112:115], v7, s[24:27], s77 offen offset:0 sc1
    buffer_store_dwordx4 v[112:115], v7, s[24:27], s78 offen offset:0 sc1
    buffer_store_dwordx4 v[112:115], v7, s[24:27], s77 offen offset:1024 sc1
    buffer_store_dwordx4 v[112:115], v7, s[24:27], s78 offen offset:1024 sc1
    buffer_store_dwordx4 v[112:115], v7, s[24:27], s77 offen offset:2048 sc1
    buffer_store_dwordx4 v[112:115], v7, s[24:27], s78 offen offset:2048 sc1
    buffer_store_dwordx4 v[112:115], v7, s[24:27], s77 offen offset:3072 sc1
    buffer_store_dwordx4 v[112:115], v7, s[24:27], s78 offen offset:3072 sc1
    s_cmp_lt_u32 s2, 216
    s_cselect_b32 s70, 2, 0
    s_cmp_lg_u32 s70, s42
    s_cbranch_scc1 L_attn_nocs
    buffer_load_dwordx4 v[24:27], v20, s[20:23], s67 offen
    s_add_u32 s67, s67, 73728
    buffer_load_dwordx4 v[28:31], v20, s[20:23], s67 offen
    s_add_u32 s67, s67, 73728
    buffer_load_dwordx4 v[32:35], v20, s[20:23], s67 offen
    s_add_u32 s67, s67, 73728
    buffer_load_dwordx4 v[36:39], v20, s[20:23], s67 offen
    s_add_u32 s67, s67, 73728
    buffer_load_dwordx4 v[40:43], v20, s[20:23], s67 offen
    s_add_u32 s67, s67, 73728
    buffer_load_dwordx4 v[44:47], v20, s[20:23], s67 offen
    s_add_u32 s67, s67, 73728
    buffer_load_dwordx4 v[48:51], v20, s[20:23], s67 offen
    s_add_u32 s67, s67, 73728
    buffer_load_dwordx4 v[52:55], v20, s[20:23], s67 offen
    s_add_u32 s67, s67, 73728
    buffer_load_dwordx4 v[56:59], v20, s[20:23], s67 offen
    s_add_u32 s67, s67, 73728
    buffer_load_dwordx4 v[60:63], v20, s[20:23], s67 offen
    s_add_u32 s67, s67, 73728
    buffer_load_dwordx4 v[64:67], v20, s[20:23], s67 offen
    s_add_u32 s67, s67, 73728
    buffer_load_dwordx4 v[68:71], v20, s[20:23], s67 offen
    s_add_u32 s67, s67, 73728
    s_waitcnt vmcnt(11)
    v_mfma_f32_16x16x32_bf16 v[12:15], v[8:11], v[24:27], 0
    s_waitcnt vmcnt(10)
    v_mfma_f32_16x16x32_bf16 v[12:15], v[8:11], v[28:31], v[12:15]
    s_waitcnt vmcnt(9)
    v_mfma_f32_16x16x32_bf16 v[12:15], v[8:11], v[32:35], v[12:15]
    s_waitcnt vmcnt(8)
    v_mfma_f32_16x16x32_bf16 v[12:15], v[8:11], v[36:39], v[12:15]
    s_waitcnt vmcnt(7)
    v_mfma_f32_16x16x32_bf16 v[12:15], v[8:11], v[40:43], v[12:15]
    s_waitcnt vmcnt(6)
    v_mfma_f32_16x16x32_bf16 v[12:15], v[8:11], v[44:47], v[12:15]
    s_waitcnt vmcnt(5)
    v_mfma_f32_16x16x32_bf16 v[12:15], v[8:11], v[48:51], v[12:15]
    s_waitcnt vmcnt(4)
    v_mfma_f32_16x16x32_bf16 v[12:15], v[8:11], v[52:55], v[12:15]
    s_waitcnt vmcnt(3)
    v_mfma_f32_16x16x32_bf16 v[12:15], v[8:11], v[56:59], v[12:15]
    s_waitcnt vmcnt(2)
    v_mfma_f32_16x16x32_bf16 v[12:15], v[8:11], v[60:63], v[12:15]
    s_waitcnt vmcnt(1)
    v_mfma_f32_16x16x32_bf16 v[12:15], v[8:11], v[64:67], v[12:15]
    s_waitcnt vmcnt(0)
    v_mfma_f32_16x16x32_bf16 v[12:15], v[8:11], v[68:71], v[12:15]
    buffer_load_dwordx4 v[24:27], v20, s[20:23], s67 offen
    s_add_u32 s67, s67, 73728
    buffer_load_dwordx4 v[28:31], v20, s[20:23], s67 offen
    s_add_u32 s67, s67, 73728
    buffer_load_dwordx4 v[32:35], v20, s[20:23], s67 offen
    s_add_u32 s67, s67, 73728
    buffer_load_dwordx4 v[36:39], v20, s[20:23], s67 offen
    s_add_u32 s67, s67, 73728
    buffer_load_dwordx4 v[40:43], v20, s[20:23], s67 offen
    s_add_u32 s67, s67, 73728
    buffer_load_dwordx4 v[44:47], v20, s[20:23], s67 offen
    s_add_u32 s67, s67, 73728
    buffer_load_dwordx4 v[48:51], v20, s[20:23], s67 offen
    s_add_u32 s67, s67, 73728
    buffer_load_dwordx4 v[52:55], v20, s[20:23], s67 offen
    s_add_u32 s67, s67, 73728
    buffer_load_dwordx4 v[56:59], v20, s[20:23], s67 offen
    s_add_u32 s67, s67, 73728
    buffer_load_dwordx4 v[60:63], v20, s[20:23], s67 offen
    s_add_u32 s67, s67, 73728
    buffer_load_dwordx4 v[64:67], v20, s[20:23], s67 offen
    s_add_u32 s67, s67, 73728
    buffer_load_dwordx4 v[68:71], v20, s[20:23], s67 offen
    s_add_u32 s67, s67, 73728
    s_waitcnt vmcnt(11)
    v_mfma_f32_16x16x32_bf16 v[12:15], v[8:11], v[24:27], v[12:15]
    s_waitcnt vmcnt(10)
    v_mfma_f32_16x16x32_bf16 v[12:15], v[8:11], v[28:31], v[12:15]
    s_waitcnt vmcnt(9)
    v_mfma_f32_16x16x32_bf16 v[12:15], v[8:11], v[32:35], v[12:15]
    s_waitcnt vmcnt(8)
    v_mfma_f32_16x16x32_bf16 v[12:15], v[8:11], v[36:39], v[12:15]
    s_waitcnt vmcnt(7)
    v_mfma_f32_16x16x32_bf16 v[12:15], v[8:11], v[40:43], v[12:15]
    s_waitcnt vmcnt(6)
    v_mfma_f32_16x16x32_bf16 v[12:15], v[8:11], v[44:47], v[12:15]
    s_waitcnt vmcnt(5)
    v_mfma_f32_16x16x32_bf16 v[12:15], v[8:11], v[48:51], v[12:15]
    s_waitcnt vmcnt(4)
    v_mfma_f32_16x16x32_bf16 v[12:15], v[8:11], v[52:55], v[12:15]
    s_waitcnt vmcnt(3)
    v_mfma_f32_16x16x32_bf16 v[12:15], v[8:11], v[56:59], v[12:15]
    s_waitcnt vmcnt(2)
    v_mfma_f32_16x16x32_bf16 v[12:15], v[8:11], v[60:63], v[12:15]
    s_waitcnt vmcnt(1)
    v_mfma_f32_16x16x32_bf16 v[12:15], v[8:11], v[64:67], v[12:15]
    s_waitcnt vmcnt(0)
    v_mfma_f32_16x16x32_bf16 v[12:15], v[8:11], v[68:71], v[12:15]
    s_nop 9
    v_add_f32_dpp v12, v12, v12 row_ror:8 row_mask:0xf bank_mask:0xf
    v_add_f32_dpp v13, v13, v13 row_ror:8 row_mask:0xf bank_mask:0xf
    v_add_f32_dpp v14, v14, v14 row_ror:8 row_mask:0xf bank_mask:0xf
    v_add_f32_dpp v15, v15, v15 row_ror:8 row_mask:0xf bank_mask:0xf
    s_mov_b64 exec, 0x00ff00ff
    buffer_store_dwordx4 v[12:15], v21, s[24:27], s71 offen sc1
    s_mov_b64 exec, -1
L_attn_nocs:
    s_waitcnt vmcnt(0)
    s_endpgm
L_attn_loader:
    s_setprio 2
    s_mul_i32 s49, s39, 288
    s_add_u32 s96, s54, s49
    s_addc_u32 s97, s55, 0
    s_sub_u32 s98, 663552, s49
    s_mov_b32 s99, 0x00020000
    s_mov_b32 s100, s41
    s_cmp_lt_u32 s39, 2
    s_cselect_b32 s101, 2, 0
    s_movk_i32 s49, 3641
    v_add_u32 v44, 0, v18
    v_mul_lo_u32 v45, v44, s49
    v_lshrrev_b32 v45, 16, v45
    v_mul_u32_u24 v45, 864, v45
    v_lshl_add_u32 v44, v44, 4, v45
    v_subrev_u32 v96, 0, v44
    v_add_u32 v44, 64, v18
    v_mul_lo_u32 v45, v44, s49
    v_lshrrev_b32 v45, 16, v45
    v_mul_u32_u24 v45, 864, v45
    v_lshl_add_u32 v44, v44, 4, v45
    v_subrev_u32 v97, 1024, v44
    v_add_u32 v44, 128, v18
    v_mul_lo_u32 v45, v44, s49
    v_lshrrev_b32 v45, 16, v45
    v_mul_u32_u24 v45, 864, v45
    v_lshl_add_u32 v44, v44, 4, v45
    v_subrev_u32 v98, 2048, v44
    v_add_u32 v44, 192, v18
    v_mul_lo_u32 v45, v44, s49
    v_lshrrev_b32 v45, 16, v45
    v_mul_u32_u24 v45, 864, v45
    v_lshl_add_u32 v44, v44, 4, v45
    v_subrev_u32 v99, 0, v44
    v_add_u32 v44, 256, v18
    v_mul_lo_u32 v45, v44, s49
    v_lshrrev_b32 v45, 16, v45
    v_mul_u32_u24 v45, 864, v45
    v_lshl_add_u32 v44, v44, 4, v45
    v_subrev_u32 v100, 1024, v44
    v_add_u32 v44, 320, v18
    v_mul_lo_u32 v45, v44, s49
    v_lshrrev_b32 v45, 16, v45
    v_mul_u32_u24 v45, 864, v45
    v_lshl_add_u32 v44, v44, 4, v45
    v_subrev_u32 v101, 2048, v44
    v_add_u32 v44, 384, v18
    v_mul_lo_u32 v45, v44, s49
    v_lshrrev_b32 v45, 16, v45
    v_mul_u32_u24 v45, 864, v45
    v_lshl_add_u32 v44, v44, 4, v45
    v_subrev_u32 v102, 0, v44
    v_add_u32 v44, 448, v18
    v_mul_lo_u32 v45, v44, s49
    v_lshrrev_b32 v45, 16, v45
    v_mul_u32_u24 v45, 864, v45
    v_lshl_add_u32 v44, v44, 4, v45
    v_subrev_u32 v103, 1024, v44
    v_add_u32 v44, 512, v18
    v_mul_lo_u32 v45, v44, s49
    v_lshrrev_b32 v45, 16, v45
    v_mul_u32_u24 v45, 864, v45
    v_lshl_add_u32 v44, v44, 4, v45
    v_subrev_u32 v104, 2048, v44
    s_mul_i32 s50, s100, 110592
    s_mov_b32 m0, 64512
    s_nop 0
    buffer_load_dwordx4 v96, s[96:99], s50 offen offset:0 lds
    buffer_load_dwordx4 v97, s[96:99], s50 offen offset:1024 lds
    buffer_load_dwordx4 v98, s[96:99], s50 offen offset:2048 lds
    s_mov_b32 m0, 67584
    s_nop 0
    buffer_load_dwordx4 v99, s[96:99], s50 offen offset:0 lds
    buffer_load_dwordx4 v100, s[96:99], s50 offen offset:1024 lds
    buffer_load_dwordx4 v101, s[96:99], s50 offen offset:2048 lds
    s_mov_b32 m0, 70656
    s_nop 0
    buffer_load_dwordx4 v102, s[96:99], s50 offen offset:0 lds
    buffer_load_dwordx4 v103, s[96:99], s50 offen offset:1024 lds
    buffer_load_dwordx4 v104, s[96:99], s50 offen offset:2048 lds
    s_add_u32 s50, s50, 36864
    s_mov_b32 m0, 73728
    s_nop 0
    buffer_load_dwordx4 v96, s[96:99], s50 offen offset:0 lds
    buffer_load_dwordx4 v97, s[96:99], s50 offen offset:1024 lds
    buffer_load_dwordx4 v98, s[96:99], s50 offen offset:2048 lds
    s_mov_b32 m0, 76800
    s_nop 0
    buffer_load_dwordx4 v99, s[96:99], s50 offen offset:0 lds
    buffer_load_dwordx4 v100, s[96:99], s50 offen offset:1024 lds
    buffer_load_dwordx4 v101, s[96:99], s50 offen offset:2048 lds
    s_mov_b32 m0, 79872
    s_nop 0
    buffer_load_dwordx4 v102, s[96:99], s50 offen offset:0 lds
    buffer_load_dwordx4 v103, s[96:99], s50 offen offset:1024 lds
    buffer_load_dwordx4 v104, s[96:99], s50 offen offset:2048 lds
    s_add_u32 s50, s50, 36864
    s_mov_b32 m0, 82944
    s_nop 0
    buffer_load_dwordx4 v96, s[96:99], s50 offen offset:0 lds
    buffer_load_dwordx4 v97, s[96:99], s50 offen offset:1024 lds
    buffer_load_dwordx4 v98, s[96:99], s50 offen offset:2048 lds
    s_mov_b32 m0, 86016
    s_nop 0
    buffer_load_dwordx4 v99, s[96:99], s50 offen offset:0 lds
    buffer_load_dwordx4 v100, s[96:99], s50 offen offset:1024 lds
    buffer_load_dwordx4 v101, s[96:99], s50 offen offset:2048 lds
    s_mov_b32 m0, 89088
    s_nop 0
    buffer_load_dwordx4 v102, s[96:99], s50 offen offset:0 lds
    buffer_load_dwordx4 v103, s[96:99], s50 offen offset:1024 lds
    buffer_load_dwordx4 v104, s[96:99], s50 offen offset:2048 lds
    s_add_u32 s100, s100, 1
    s_cmp_eq_u32 s100, 6
    s_cselect_b32 s100, 0, s100
    s_mov_b32 s20, s28
    s_mov_b32 s21, s29
    s_mov_b32 s22, 256
    s_mov_b32 s23, 0x00020000
    s_mov_b32 s32, s30
    s_mov_b32 s33, s31
    s_mov_b32 s78, s52
    s_mov_b32 s79, s53
    s_add_u32 s8, s32, 2359296
    s_addc_u32 s9, s33, 0
    s_mov_b32 s10, 151552
    s_mov_b32 s11, 0x00020000
    s_load_dwordx2 s[4:5], s[0:1], 32
    s_load_dwordx2 s[6:7], s[0:1], 48
    s_load_dwordx2 s[28:29], s[0:1], 64
    s_load_dwordx2 s[30:31], s[0:1], 56
    s_load_dwordx4 s[12:15], s[0:1], 72
    v_lshlrev_b32 v93, 2, v18
    v_mov_b32 v95, 163824
    s_waitcnt lgkmcnt(0)
    s_lshr_b32 s52, s2, 4
    s_and_b32 s53, s2, 15
    s_and_b32 s54, s52, 7
    s_mul_i32 s55, s54, 1152
    s_mul_i32 s56, s54, 663552
    s_cmp_ge_u32 s52, 8
    s_cselect_b32 s16, s28, s6
    s_cselect_b32 s17, s29, s7
    s_cselect_b32 s55, s56, s55
    s_movk_i32 s57, 9216
    s_cselect_b32 s57, 1152, s57
    s_mov_b32 s18, 5308416
    s_mov_b32 s19, 0x00020000
    s_lshl_b32 s58, s57, 5
    s_mul_i32 s59, s52, 663552
    s_add_u32 s59, s59, 26345472
    v_lshrrev_b32 v25, 3, v18
    v_and_b32 v26, 7, v18
    v_bfe_u32 v27, v18, 4, 2
    v_lshlrev_b32 v27, 1, v27
    v_xor_b32 v26, v26, v27
    v_lshlrev_b32 v26, 4, v26
    v_mul_lo_u32 v105, v25, s57
    v_add_u32 v105, v105, v26
    s_lshl_b32 s60, s57, 3
    s_sub_u32 s60, s60, 1024
    v_add_u32 v106, s60, v105
    v_add_u32 v107, s60, v106
    v_add_u32 v108, s60, v107
    v_lshrrev_b32 v27, 2, v18
    v_lshlrev_b32 v24, 7, v27
    v_bfe_u32 v27, v27, 1, 2
    v_lshl_add_u32 v24, v27, 5, v24
    v_and_b32 v27, 3, v18
    v_lshl_add_u32 v24, v27, 3, v24
    v_xor_b32 v20, 0, v24
    v_add_u32 v20, 151552, v20
    v_xor_b32 v21, 32, v24
    v_add_u32 v21, 151552, v21
    v_xor_b32 v22, 64, v24
    v_add_u32 v22, 151552, v22
    v_xor_b32 v23, 96, v24
    v_add_u32 v23, 151552, v23
    v_mul_u32_u24 v30, 1152, v25
    v_add_u32 v30, v30, v26
    v_bfe_u32 v27, v25, 2, 1
    v_lshlrev_b32 v27, 2, v27
    v_bfe_u32 v28, v25, 1, 1
    v_add_u32 v27, v27, v28
    v_mul_u32_u24 v27, 18, v27
    v_and_b32 v28, 1, v25
    v_add3_u32 v27, v27, v28, 16
    v_mul_u32_u24 v27, 1152, v27
    v_add_u32 v27, v27, v26
    s_mul_i32 s63, s2, 3641
    s_lshr_b32 s63, s63, 16
    s_mul_i32 s64, s63, 18
    s_sub_u32 s64, s2, s64
    s_mul_i32 s65, s64, 41472
    s_sub_u32 s66, s64, 16
    s_mul_i32 s66, s66, 331776
    s_movk_i32 s41, 19712
    s_movk_i32 s42, 7168
    s_movk_i32 s43, 26880
    s_cmp_ge_u32 s64, 16
    s_cselect_b32 s65, s66, s65
    s_cselect_b32 s41, 164864, s41
    s_cselect_b32 s42, 39424, s42
    s_cselect_b32 s43, 204288, s43
    s_cselect_b64 s[68:69], -1, 0
    v_cndmask_b32 v28, v30, v27, s[68:69]
    s_lshl_b32 s66, s63, 7
    s_add_u32 s65, s65, s66
    s_cmp_lt_u32 s2, 162
    s_cselect_b32 s40, s65, 0x40000000
    s_add_u32 s41, s41, s40
    s_add_u32 s42, s42, s40
    s_add_u32 s43, s43, s40
    s_mul_i32 s65, s63, 18432
    s_lshl_b32 s66, s64, 10
    s_add_u32 s65, s65, s66
    s_add_u32 s65, s65, 36962304
    s_cmp_lt_u32 s2, 162
    s_cselect_b32 s44, s65, 0x40000000
    v_mov_b32 v112, -1
    v_mov_b32 v113, -1
    v_mov_b32 v114, -1
    v_mov_b32 v115, -1
    v_lshlrev_b32 v116, 7, v18
    v_mul_u32_u24 v118, 1152, v18
    v_lshlrev_b32 v119, 20, v18
    v_min_u32 v120, 1024, v116
    v_and_b32 v121, 1, v18
    v_lshlrev_b32 v121, 21, v121
    v_add_u32 v122, 8192, v116
    v_add_u32 v123, 16384, v116
    v_min_u32 v123, 20220, v123
    s_mov_b32 s61, s53
    s_mov_b32 s62, s53
    s_mul_i32 s50, s100, 110592
    s_mov_b32 m0, 92160
    s_nop 0
    buffer_load_dwordx4 v96, s[96:99], s50 offen offset:0 lds
    buffer_load_dwordx4 v97, s[96:99], s50 offen offset:1024 lds
    buffer_load_dwordx4 v98, s[96:99], s50 offen offset:2048 lds
    s_mov_b32 m0, 95232
    s_nop 0
    buffer_load_dwordx4 v99, s[96:99], s50 offen offset:0 lds
    buffer_load_dwordx4 v100, s[96:99], s50 offen offset:1024 lds
    buffer_load_dwordx4 v101, s[96:99], s50 offen offset:2048 lds
    s_mov_b32 m0, 98304
    s_nop 0
    buffer_load_dwordx4 v102, s[96:99], s50 offen offset:0 lds
    buffer_load_dwordx4 v103, s[96:99], s50 offen offset:1024 lds
    buffer_load_dwordx4 v104, s[96:99], s50 offen offset:2048 lds
    s_add_u32 s50, s50, 36864
    s_mov_b32 m0, 101376
    s_nop 0
    buffer_load_dwordx4 v96, s[96:99], s50 offen offset:0 lds
    buffer_load_dwordx4 v97, s[96:99], s50 offen offset:1024 lds
    buffer_load_dwordx4 v98, s[96:99], s50 offen offset:2048 lds
    s_mov_b32 m0, 104448
    s_nop 0
    buffer_load_dwordx4 v99, s[96:99], s50 offen offset:0 lds
    buffer_load_dwordx4 v100, s[96:99], s50 offen offset:1024 lds
    buffer_load_dwordx4 v101, s[96:99], s50 offen offset:2048 lds
    s_mov_b32 m0, 107520
    s_nop 0
    buffer_load_dwordx4 v102, s[96:99], s50 offen offset:0 lds
    buffer_load_dwordx4 v103, s[96:99], s50 offen offset:1024 lds
    buffer_load_dwordx4 v104, s[96:99], s50 offen offset:2048 lds
    s_add_u32 s50, s50, 36864
    s_mov_b32 m0, 110592
    s_nop 0
    buffer_load_dwordx4 v96, s[96:99], s50 offen offset:0 lds
    buffer_load_dwordx4 v97, s[96:99], s50 offen offset:1024 lds
    buffer_load_dwordx4 v98, s[96:99], s50 offen offset:2048 lds
    s_mov_b32 m0, 113664
    s_nop 0
    buffer_load_dwordx4 v99, s[96:99], s50 offen offset:0 lds
    buffer_load_dwordx4 v100, s[96:99], s50 offen offset:1024 lds
    buffer_load_dwordx4 v101, s[96:99], s50 offen offset:2048 lds
    s_mov_b32 m0, 116736
    s_nop 0
    buffer_load_dwordx4 v102, s[96:99], s50 offen offset:0 lds
    buffer_load_dwordx4 v103, s[96:99], s50 offen offset:1024 lds
    buffer_load_dwordx4 v104, s[96:99], s50 offen offset:2048 lds
    s_add_u32 s100, s100, 1
    s_cmp_eq_u32 s100, 6
    s_cselect_b32 s100, 0, s100
    s_waitcnt vmcnt(27)
    v_mov_b32 v44, 1
    ds_write_b32 v92, v44 offset:36
    s_mul_i32 s50, s100, 110592
    s_mov_b32 m0, 119808
    s_nop 0
    buffer_load_dwordx4 v96, s[96:99], s50 offen offset:0 lds
    buffer_load_dwordx4 v97, s[96:99], s50 offen offset:1024 lds
    buffer_load_dwordx4 v98, s[96:99], s50 offen offset:2048 lds
    s_mov_b32 m0, 122880
    s_nop 0
    buffer_load_dwordx4 v99, s[96:99], s50 offen offset:0 lds
    buffer_load_dwordx4 v100, s[96:99], s50 offen offset:1024 lds
    buffer_load_dwordx4 v101, s[96:99], s50 offen offset:2048 lds
    s_mov_b32 m0, 125952
    s_nop 0
    buffer_load_dwordx4 v102, s[96:99], s50 offen offset:0 lds
    buffer_load_dwordx4 v103, s[96:99], s50 offen offset:1024 lds
    buffer_load_dwordx4 v104, s[96:99], s50 offen offset:2048 lds
    s_add_u32 s50, s50, 36864
    s_mov_b32 m0, 129024
    s_nop 0
    buffer_load_dwordx4 v96, s[96:99], s50 offen offset:0 lds
    buffer_load_dwordx4 v97, s[96:99], s50 offen offset:1024 lds
    buffer_load_dwordx4 v98, s[96:99], s50 offen offset:2048 lds
    s_mov_b32 m0, 132096
    s_nop 0
    buffer_load_dwordx4 v99, s[96:99], s50 offen offset:0 lds
    buffer_load_dwordx4 v100, s[96:99], s50 offen offset:1024 lds
    buffer_load_dwordx4 v101, s[96:99], s50 offen offset:2048 lds
    s_mov_b32 m0, 135168
    s_nop 0
    buffer_load_dwordx4 v102, s[96:99], s50 offen offset:0 lds
    buffer_load_dwordx4 v103, s[96:99], s50 offen offset:1024 lds
    buffer_load_dwordx4 v104, s[96:99], s50 offen offset:2048 lds
    s_add_u32 s50, s50, 36864
    s_mov_b32 m0, 138240
    s_nop 0
    buffer_load_dwordx4 v96, s[96:99], s50 offen offset:0 lds
    buffer_load_dwordx4 v97, s[96:99], s50 offen offset:1024 lds
    buffer_load_dwordx4 v98, s[96:99], s50 offen offset:2048 lds
    s_mov_b32 m0, 141312
    s_nop 0
    buffer_load_dwordx4 v99, s[96:99], s50 offen offset:0 lds
    buffer_load_dwordx4 v100, s[96:99], s50 offen offset:1024 lds
    buffer_load_dwordx4 v101, s[96:99], s50 offen offset:2048 lds
    s_mov_b32 m0, 144384
    s_nop 0
    buffer_load_dwordx4 v102, s[96:99], s50 offen offset:0 lds
    buffer_load_dwordx4 v103, s[96:99], s50 offen offset:1024 lds
    buffer_load_dwordx4 v104, s[96:99], s50 offen offset:2048 lds
    s_add_u32 s100, s100, 1
    s_cmp_eq_u32 s100, 6
    s_cselect_b32 s100, 0, s100
    s_waitcnt vmcnt(27)
    v_mov_b32 v44, 2
    ds_write_b32 v92, v44 offset:36
L_attn_f2:
    ds_read_b32 v44, v92 offset:20
    s_waitcnt lgkmcnt(0)
    v_readfirstlane_b32 s49, v44
    s_nop 0
    s_cmp_lt_u32 s49, s101
    s_cbranch_scc1 L_attn_f2
    s_mul_i32 s50, s100, 110592
    s_mov_b32 m0, 0
    s_nop 0
    buffer_load_dwordx4 v96, s[96:99], s50 offen offset:0 lds
    buffer_load_dwordx4 v97, s[96:99], s50 offen offset:1024 lds
    buffer_load_dwordx4 v98, s[96:99], s50 offen offset:2048 lds
    s_mov_b32 m0, 3072
    s_nop 0
    buffer_load_dwordx4 v99, s[96:99], s50 offen offset:0 lds
    buffer_load_dwordx4 v100, s[96:99], s50 offen offset:1024 lds
    buffer_load_dwordx4 v101, s[96:99], s50 offen offset:2048 lds
    s_mov_b32 m0, 6144
    s_nop 0
    buffer_load_dwordx4 v102, s[96:99], s50 offen offset:0 lds
    buffer_load_dwordx4 v103, s[96:99], s50 offen offset:1024 lds
    buffer_load_dwordx4 v104, s[96:99], s50 offen offset:2048 lds
    s_add_u32 s50, s50, 36864
    s_mov_b32 m0, 9216
    s_nop 0
    buffer_load_dwordx4 v96, s[96:99], s50 offen offset:0 lds
    buffer_load_dwordx4 v97, s[96:99], s50 offen offset:1024 lds
    buffer_load_dwordx4 v98, s[96:99], s50 offen offset:2048 lds
    s_mov_b32 m0, 12288
    s_nop 0
    buffer_load_dwordx4 v99, s[96:99], s50 offen offset:0 lds
    buffer_load_dwordx4 v100, s[96:99], s50 offen offset:1024 lds
    buffer_load_dwordx4 v101, s[96:99], s50 offen offset:2048 lds
    s_mov_b32 m0, 15360
    s_nop 0
    buffer_load_dwordx4 v102, s[96:99], s50 offen offset:0 lds
    buffer_load_dwordx4 v103, s[96:99], s50 offen offset:1024 lds
    buffer_load_dwordx4 v104, s[96:99], s50 offen offset:2048 lds
    s_add_u32 s50, s50, 36864
    s_mov_b32 m0, 18432
    s_nop 0
    buffer_load_dwordx4 v96, s[96:99], s50 offen offset:0 lds
    buffer_load_dwordx4 v97, s[96:99], s50 offen offset:1024 lds
    buffer_load_dwordx4 v98, s[96:99], s50 offen offset:2048 lds
    s_mov_b32 m0, 21504
    s_nop 0
    buffer_load_dwordx4 v99, s[96:99], s50 offen offset:0 lds
    buffer_load_dwordx4 v100, s[96:99], s50 offen offset:1024 lds
    buffer_load_dwordx4 v101, s[96:99], s50 offen offset:2048 lds
    s_mov_b32 m0, 24576
    s_nop 0
    buffer_load_dwordx4 v102, s[96:99], s50 offen offset:0 lds
    buffer_load_dwordx4 v103, s[96:99], s50 offen offset:1024 lds
    buffer_load_dwordx4 v104, s[96:99], s50 offen offset:2048 lds
    s_add_u32 s100, s100, 1
    s_cmp_eq_u32 s100, 6
    s_cselect_b32 s100, 0, s100
    s_waitcnt vmcnt(27)
    v_mov_b32 v44, 3
    ds_write_b32 v92, v44 offset:36
L_attn_f3:
    ds_read_b32 v44, v92 offset:0
    s_waitcnt lgkmcnt(0)
    v_readfirstlane_b32 s49, v44
    s_nop 0
    s_cmp_lt_u32 s49, 8
    s_cbranch_scc1 L_attn_f3
    s_mul_i32 s50, s100, 110592
    s_mov_b32 m0, 64512
    s_nop 0
    buffer_load_dwordx4 v96, s[96:99], s50 offen offset:0 lds
    buffer_load_dwordx4 v97, s[96:99], s50 offen offset:1024 lds
    buffer_load_dwordx4 v98, s[96:99], s50 offen offset:2048 lds
    s_mov_b32 m0, 67584
    s_nop 0
    buffer_load_dwordx4 v99, s[96:99], s50 offen offset:0 lds
    buffer_load_dwordx4 v100, s[96:99], s50 offen offset:1024 lds
    buffer_load_dwordx4 v101, s[96:99], s50 offen offset:2048 lds
    s_mov_b32 m0, 70656
    s_nop 0
    buffer_load_dwordx4 v102, s[96:99], s50 offen offset:0 lds
    buffer_load_dwordx4 v103, s[96:99], s50 offen offset:1024 lds
    buffer_load_dwordx4 v104, s[96:99], s50 offen offset:2048 lds
    s_add_u32 s50, s50, 36864
    s_mov_b32 m0, 73728
    s_nop 0
    buffer_load_dwordx4 v96, s[96:99], s50 offen offset:0 lds
    buffer_load_dwordx4 v97, s[96:99], s50 offen offset:1024 lds
    buffer_load_dwordx4 v98, s[96:99], s50 offen offset:2048 lds
    s_mov_b32 m0, 76800
    s_nop 0
    buffer_load_dwordx4 v99, s[96:99], s50 offen offset:0 lds
    buffer_load_dwordx4 v100, s[96:99], s50 offen offset:1024 lds
    buffer_load_dwordx4 v101, s[96:99], s50 offen offset:2048 lds
    s_mov_b32 m0, 79872
    s_nop 0
    buffer_load_dwordx4 v102, s[96:99], s50 offen offset:0 lds
    buffer_load_dwordx4 v103, s[96:99], s50 offen offset:1024 lds
    buffer_load_dwordx4 v104, s[96:99], s50 offen offset:2048 lds
    s_add_u32 s50, s50, 36864
    s_mov_b32 m0, 82944
    s_nop 0
    buffer_load_dwordx4 v96, s[96:99], s50 offen offset:0 lds
    buffer_load_dwordx4 v97, s[96:99], s50 offen offset:1024 lds
    buffer_load_dwordx4 v98, s[96:99], s50 offen offset:2048 lds
    s_mov_b32 m0, 86016
    s_nop 0
    buffer_load_dwordx4 v99, s[96:99], s50 offen offset:0 lds
    buffer_load_dwordx4 v100, s[96:99], s50 offen offset:1024 lds
    buffer_load_dwordx4 v101, s[96:99], s50 offen offset:2048 lds
    s_mov_b32 m0, 89088
    s_nop 0
    buffer_load_dwordx4 v102, s[96:99], s50 offen offset:0 lds
    buffer_load_dwordx4 v103, s[96:99], s50 offen offset:1024 lds
    buffer_load_dwordx4 v104, s[96:99], s50 offen offset:2048 lds
    s_add_u32 s100, s100, 1
    s_cmp_eq_u32 s100, 6
    s_cselect_b32 s100, 0, s100
    s_waitcnt vmcnt(27)
    v_mov_b32 v44, 4
    ds_write_b32 v92, v44 offset:36
L_attn_f4:
    ds_read_b32 v44, v92 offset:4
    s_waitcnt lgkmcnt(0)
    v_readfirstlane_b32 s49, v44
    s_nop 0
    s_cmp_lt_u32 s49, 8
    s_cbranch_scc1 L_attn_f4
    s_mul_i32 s50, s100, 110592
    s_mov_b32 m0, 92160
    s_nop 0
    buffer_load_dwordx4 v96, s[96:99], s50 offen offset:0 lds
    buffer_load_dwordx4 v97, s[96:99], s50 offen offset:1024 lds
    buffer_load_dwordx4 v98, s[96:99], s50 offen offset:2048 lds
    s_mov_b32 m0, 95232
    s_nop 0
    buffer_load_dwordx4 v99, s[96:99], s50 offen offset:0 lds
    buffer_load_dwordx4 v100, s[96:99], s50 offen offset:1024 lds
    buffer_load_dwordx4 v101, s[96:99], s50 offen offset:2048 lds
    s_mov_b32 m0, 98304
    s_nop 0
    buffer_load_dwordx4 v102, s[96:99], s50 offen offset:0 lds
    buffer_load_dwordx4 v103, s[96:99], s50 offen offset:1024 lds
    buffer_load_dwordx4 v104, s[96:99], s50 offen offset:2048 lds
    s_add_u32 s50, s50, 36864
    s_mov_b32 m0, 101376
    s_nop 0
    buffer_load_dwordx4 v96, s[96:99], s50 offen offset:0 lds
    buffer_load_dwordx4 v97, s[96:99], s50 offen offset:1024 lds
    buffer_load_dwordx4 v98, s[96:99], s50 offen offset:2048 lds
    s_mov_b32 m0, 104448
    s_nop 0
    buffer_load_dwordx4 v99, s[96:99], s50 offen offset:0 lds
    buffer_load_dwordx4 v100, s[96:99], s50 offen offset:1024 lds
    buffer_load_dwordx4 v101, s[96:99], s50 offen offset:2048 lds
    s_mov_b32 m0, 107520
    s_nop 0
    buffer_load_dwordx4 v102, s[96:99], s50 offen offset:0 lds
    buffer_load_dwordx4 v103, s[96:99], s50 offen offset:1024 lds
    buffer_load_dwordx4 v104, s[96:99], s50 offen offset:2048 lds
    s_add_u32 s50, s50, 36864
    s_mov_b32 m0, 110592
    s_nop 0
    buffer_load_dwordx4 v96, s[96:99], s50 offen offset:0 lds
    buffer_load_dwordx4 v97, s[96:99], s50 offen offset:1024 lds
    buffer_load_dwordx4 v98, s[96:99], s50 offen offset:2048 lds
    s_mov_b32 m0, 113664
    s_nop 0
    buffer_load_dwordx4 v99, s[96:99], s50 offen offset:0 lds
    buffer_load_dwordx4 v100, s[96:99], s50 offen offset:1024 lds
    buffer_load_dwordx4 v101, s[96:99], s50 offen offset:2048 lds
    s_mov_b32 m0, 116736
    s_nop 0
    buffer_load_dwordx4 v102, s[96:99], s50 offen offset:0 lds
    buffer_load_dwordx4 v103, s[96:99], s50 offen offset:1024 lds
    buffer_load_dwordx4 v104, s[96:99], s50 offen offset:2048 lds
    s_add_u32 s100, s100, 1
    s_cmp_eq_u32 s100, 6
    s_cselect_b32 s100, 0, s100
    s_waitcnt vmcnt(27)
    v_mov_b32 v44, 5
    ds_write_b32 v92, v44 offset:36
    buffer_load_dword v94, v64, s[20:23], 0 offen offset:128 sc1
    s_waitcnt vmcnt(1)
    v_mov_b32 v44, 6
    ds_write_b32 v92, v44 offset:36
    s_mov_b32 s50, 2515968
    buffer_load_dword v117, v116, s[24:27], s50 offen sc1
    s_movk_i32 s50, 0
    buffer_load_dword v117, v116, s[8:11], s50 offen sc1
    s_movk_i32 s50, 8192
    buffer_load_dword v117, v116, s[8:11], s50 offen sc1
    s_movk_i32 s50, 16384
    buffer_load_dword v117, v116, s[8:11], s50 offen sc1
    s_mov_b32 s71, 0x8000
L_attn_poll:
    s_waitcnt vmcnt(0)
    v_readfirstlane_b32 s49, v94
    s_sub_u32 s71, s71, 1
    s_cmp_lg_u32 s49, 0
    s_cbranch_scc1 L_attn_pollx
    s_cmp_eq_u32 s71, 0
    s_cbranch_scc1 L_attn_pollx
    s_sleep 2
    buffer_load_dword v94, v64, s[20:23], 0 offen offset:128 sc1
    s_branch L_attn_poll
L_attn_pollx:
    ds_read_b32 v44, v92 offset:8
    s_waitcnt lgkmcnt(0)
    v_readfirstlane_b32 s49, v44
    s_nop 0
    s_cmp_lt_u32 s49, 8
    s_cbranch_scc1 L_attn_pollx
    s_mov_b32 s50, 2515968
    buffer_load_dword v44, v116, s[24:27], s50 offen sc1
    s_mov_b32 s50, 0
    s_mov_b32 s71, 6
L_attn_ld1:
    s_mov_b32 m0, s50
    s_sub_u32 s71, s71, 1
    buffer_load_dwordx4 v7, s[8:11], s50 offen offset:0 sc1 lds
    buffer_load_dwordx4 v7, s[8:11], s50 offen offset:1024 sc1 lds
    buffer_load_dwordx4 v7, s[8:11], s50 offen offset:2048 sc1 lds
    buffer_load_dwordx4 v7, s[8:11], s50 offen offset:3072 sc1 lds
    s_add_u32 s50, s50, 4096
    s_waitcnt vmcnt(40)
    s_cmp_lg_u32 s71, 0
    s_cbranch_scc1 L_attn_ld1
    s_waitcnt vmcnt(24)
    s_nop 1
    v_max_u32_dpp v44, v44, v44 row_ror:1 row_mask:0xf bank_mask:0xf
    s_nop 1
    v_max_u32_dpp v44, v44, v44 row_ror:2 row_mask:0xf bank_mask:0xf
    s_nop 1
    v_max_u32_dpp v44, v44, v44 row_ror:4 row_mask:0xf bank_mask:0xf
    s_nop 1
    v_max_u32_dpp v44, v44, v44 row_ror:8 row_mask:0xf bank_mask:0xf
    s_nop 0
    v_readlane_b32 s63, v44, 0
    v_readlane_b32 s64, v44, 16
    v_readlane_b32 s65, v44, 32
    v_readlane_b32 s66, v44, 48
    s_nop 1
    s_max_u32 s63, s63, s64
    s_max_u32 s65, s65, s66
    s_max_u32 s63, s63, s65
    v_mov_b32 v44, s63
    ds_write_b32 v95, v44
    s_waitcnt lgkmcnt(0)
    s_waitcnt vmcnt(0)
    s_barrier
    s_setprio 0
    s_mov_b32 s71, 11
L_attn_ld2:
    s_mov_b32 m0, s50
    s_sub_u32 s71, s71, 1
    buffer_load_dwordx4 v7, s[8:11], s50 offen offset:0 sc1 lds
    buffer_load_dwordx4 v7, s[8:11], s50 offen offset:1024 sc1 lds
    buffer_load_dwordx4 v7, s[8:11], s50 offen offset:2048 sc1 lds
    buffer_load_dwordx4 v7, s[8:11], s50 offen offset:3072 sc1 lds
    s_add_u32 s50, s50, 4096
    s_waitcnt vmcnt(40)
    s_cmp_lg_u32 s71, 0
    s_cbranch_scc1 L_attn_ld2
    s_waitcnt vmcnt(0)
    s_barrier
    s_mul_i32 s63, s61, 3641
    s_lshr_b32 s63, s63, 16
    s_mul_i32 s64, s63, 18
    s_sub_u32 s64, s61, s64
    s_mul_i32 s65, s64, s58
    s_lshl_b32 s66, s63, 7
    s_add_u32 s65, s65, s66
    s_add_u32 s65, s65, s55
    s_cmp_lt_u32 s61, 162
    s_cselect_b32 s65, s65, 0x40000000
    s_mov_b32 m0, 151552
    s_add_u32 s61, s61, 16
    buffer_load_dwordx4 v105, s[16:19], s65 offen offset:0 lds
    buffer_load_dwordx4 v106, s[16:19], s65 offen offset:1024 lds
    buffer_load_dwordx4 v107, s[16:19], s65 offen offset:2048 lds
    buffer_load_dwordx4 v108, s[16:19], s65 offen offset:3072 lds
    s_mul_i32 s63, s61, 3641
    s_lshr_b32 s63, s63, 16
    s_mul_i32 s64, s63, 18
    s_sub_u32 s64, s61, s64
    s_mul_i32 s65, s64, s58
    s_lshl_b32 s66, s63, 7
    s_add_u32 s65, s65, s66
    s_add_u32 s65, s65, s55
    s_cmp_lt_u32 s61, 162
    s_cselect_b32 s65, s65, 0x40000000
    s_mov_b32 m0, 155648
    s_add_u32 s61, s61, 16
    buffer_load_dwordx4 v105, s[16:19], s65 offen offset:0 lds
    buffer_load_dwordx4 v106, s[16:19], s65 offen offset:1024 lds
    buffer_load_dwordx4 v107, s[16:19], s65 offen offset:2048 lds
    buffer_load_dwordx4 v108, s[16:19], s65 offen offset:3072 lds
    s_mul_i32 s63, s61, 3641
    s_lshr_b32 s63, s63, 16
    s_mul_i32 s64, s63, 18
    s_sub_u32 s64, s61, s64
    s_mul_i32 s65, s64, s58
    s_lshl_b32 s66, s63, 7
    s_add_u32 s65, s65, s66
    s_add_u32 s65, s65, s55
    s_cmp_lt_u32 s61, 162
    s_cselect_b32 s65, s65, 0x40000000
    s_mov_b32 m0, 159744
    s_add_u32 s61, s61, 16
    buffer_load_dwordx4 v105, s[16:19], s65 offen offset:0 lds
    buffer_load_dwordx4 v106, s[16:19], s65 offen offset:1024 lds
    buffer_load_dwordx4 v107, s[16:19], s65 offen offset:2048 lds
    buffer_load_dwordx4 v108, s[16:19], s65 offen offset:3072 lds
    s_mul_i32 s63, s2, 144
    s_add_u32 s63, s63, 2715648
    s_mov_b64 exec, 0x1ff
    buffer_store_dwordx4 v[64:67], v7, s[24:27], s63 offen sc1
    s_mov_b64 exec, -1
    s_mov_b32 s20, s78
    s_mov_b32 s21, s79
    s_mov_b32 s22, 2359296
    s_mov_b32 s23, 0x00020000
    s_and_b32 s63, s2, 1
    s_lshl_b32 s63, s63, 2
    s_and_b32 s64, s35, 3
    s_add_u32 s63, s63, s64
    s_andn2_b32 s64, s35, 3
    s_bfe_u32 s65, s2, 0x20001
    s_add_u32 s64, s64, s65
    s_mul_i32 s64, s64, 73728
    s_lshl_b32 s63, s63, 7
    s_add_u32 s63, s63, s64
    buffer_load_dword v117, v118, s[20:23], s63 offen
    buffer_load_dword v117, v118, s[20:23], s64 offen offset:1024
    buffer_load_dword v117, v119, s[24:27], 0 offen
    global_load_dword v117, v116, s[30:31]
    global_load_dword v117, v116, s[30:31] offset:1024
    global_load_dword v117, v120, s[12:13]
    global_load_dword v117, v121, s[14:15]
    s_getpc_b64 s[66:67]
L_pc_k2:
    s_add_u32 s66, s66, ffn_kernel-L_pc_k2
    s_addc_u32 s67, s67, 0
    global_load_dword v117, v116, s[66:67]
    global_load_dword v117, v122, s[66:67]
    global_load_dword v117, v123, s[66:67]
    s_waitcnt vmcnt(11)
    s_mul_i32 s74, s34, 2359296
    s_mul_i32 s75, s35, 73728
    s_add_u32 s74, s74, s75
    s_add_u32 s74, s74, 7471104
    s_lshl_b32 s76, s34, 12
    s_add_u32 s76, s76, s75
    s_add_u32 s76, s76, 5111808
    s_mov_b32 s12, s4
    s_mov_b32 s13, s5
    s_mov_b32 s14, 663552
    s_mov_b32 s15, 0x00020000
    s_mov_b32 s71, 4
L_attn_tr:
    s_waitcnt vmcnt(12)
    ds_read_b64_tr_b16 v[32:33], v20 offset:0
    ds_read_b64_tr_b16 v[34:35], v20 offset:2048
    ds_read_b64_tr_b16 v[36:37], v21 offset:0
    ds_read_b64_tr_b16 v[38:39], v21 offset:2048
    ds_read_b64_tr_b16 v[40:41], v22 offset:0
    ds_read_b64_tr_b16 v[42:43], v22 offset:2048
    ds_read_b64_tr_b16 v[44:45], v23 offset:0
    ds_read_b64_tr_b16 v[46:47], v23 offset:2048
    ds_read_b64_tr_b16 v[48:49], v20 offset:4096
    ds_read_b64_tr_b16 v[50:51], v20 offset:6144
    ds_read_b64_tr_b16 v[52:53], v21 offset:4096
    ds_read_b64_tr_b16 v[54:55], v21 offset:6144
    ds_read_b64_tr_b16 v[56:57], v22 offset:4096
    ds_read_b64_tr_b16 v[58:59], v22 offset:6144
    ds_read_b64_tr_b16 v[60:61], v23 offset:4096
    ds_read_b64_tr_b16 v[62:63], v23 offset:6144
    ds_read_b64_tr_b16 v[64:65], v20 offset:8192
    ds_read_b64_tr_b16 v[66:67], v20 offset:10240
    ds_read_b64_tr_b16 v[68:69], v21 offset:8192
    ds_read_b64_tr_b16 v[70:71], v21 offset:10240
    ds_read_b64_tr_b16 v[72:73], v22 offset:8192
    ds_read_b64_tr_b16 v[74:75], v22 offset:10240
    ds_read_b64_tr_b16 v[76:77], v23 offset:8192
    ds_read_b64_tr_b16 v[78:79], v23 offset:10240
    s_waitcnt lgkmcnt(0)
    s_cmp_eq_u32 s71, 1
    s_cbranch_scc1 L_attn_trwo
    s_mul_i32 s63, s61, 3641
    s_lshr_b32 s63, s63, 16
    s_mul_i32 s64, s63, 18
    s_sub_u32 s64, s61, s64
    s_mul_i32 s65, s64, s58
    s_lshl_b32 s66, s63, 7
    s_add_u32 s65, s65, s66
    s_add_u32 s65, s65, s55
    s_cmp_lt_u32 s61, 162
    s_cselect_b32 s65, s65, 0x40000000
    s_mov_b32 m0, 151552
    s_add_u32 s61, s61, 16
    buffer_load_dwordx4 v105, s[16:19], s65 offen offset:0 lds
    buffer_load_dwordx4 v106, s[16:19], s65 offen offset:1024 lds
    buffer_load_dwordx4 v107, s[16:19], s65 offen offset:2048 lds
    buffer_load_dwordx4 v108, s[16:19], s65 offen offset:3072 lds
    s_mul_i32 s63, s61, 3641
    s_lshr_b32 s63, s63, 16
    s_mul_i32 s64, s63, 18
    s_sub_u32 s64, s61, s64
    s_mul_i32 s65, s64, s58
    s_lshl_b32 s66, s63, 7
    s_add_u32 s65, s65, s66
    s_add_u32 s65, s65, s55
    s_cmp_lt_u32 s61, 162
    s_cselect_b32 s65, s65, 0x40000000
    s_mov_b32 m0, 155648
    s_add_u32 s61, s61, 16
    buffer_load_dwordx4 v105, s[16:19], s65 offen offset:0 lds
    buffer_load_dwordx4 v106, s[16:19], s65 offen offset:1024 lds
    buffer_load_dwordx4 v107, s[16:19], s65 offen offset:2048 lds
    buffer_load_dwordx4 v108, s[16:19], s65 offen offset:3072 lds
    s_mul_i32 s63, s61, 3641
    s_lshr_b32 s63, s63, 16
    s_mul_i32 s64, s63, 18
    s_sub_u32 s64, s61, s64
    s_mul_i32 s65, s64, s58
    s_lshl_b32 s66, s63, 7
    s_add_u32 s65, s65, s66
    s_add_u32 s65, s65, s55
    s_cmp_lt_u32 s61, 162
    s_cselect_b32 s65, s65, 0x40000000
    s_mov_b32 m0, 159744
    s_add_u32 s61, s61, 16
    buffer_load_dwordx4 v105, s[16:19], s65 offen offset:0 lds
    buffer_load_dwordx4 v106, s[16:19], s65 offen offset:1024 lds
    buffer_load_dwordx4 v107, s[16:19], s65 offen offset:2048 lds
    buffer_load_dwordx4 v108, s[16:19], s65 offen offset:3072 lds
    s_branch L_attn_trst
L_attn_trwo:
    s_mov_b32 m0, 151552
    s_nop 0
    buffer_load_dwordx4 v28, s[12:15], s40 offen offset:0 lds
    buffer_load_dwordx4 v28, s[12:15], s41 offen offset:1024 lds
    buffer_load_dwordx4 v28, s[12:15], s42 offen offset:2048 lds
    buffer_load_dwordx4 v28, s[12:15], s43 offen offset:3072 lds
L_attn_trst:
    s_mul_i32 s63, s62, 3641
    s_lshr_b32 s63, s63, 16
    s_mul_i32 s64, s63, 18
    s_sub_u32 s64, s62, s64
    s_mul_i32 s65, s63, 18432
    s_lshl_b32 s66, s64, 10
    s_add_u32 s65, s65, s66
    s_add_u32 s65, s65, s59
    s_cmp_lt_u32 s62, 162
    s_cselect_b32 s65, s65, 0x40000000
    s_add_u32 s62, s62, 16
    buffer_store_dwordx4 v[32:35], v7, s[24:27], s65 offen sc1
    s_add_u32 s65, s65, 165888
    buffer_store_dwordx4 v[36:39], v7, s[24:27], s65 offen sc1
    s_add_u32 s65, s65, 165888
    buffer_store_dwordx4 v[40:43], v7, s[24:27], s65 offen sc1
    s_add_u32 s65, s65, 165888
    buffer_store_dwordx4 v[44:47], v7, s[24:27], s65 offen sc1
    s_mul_i32 s63, s62, 3641
    s_lshr_b32 s63, s63, 16
    s_mul_i32 s64, s63, 18
    s_sub_u32 s64, s62, s64
    s_mul_i32 s65, s63, 18432
    s_lshl_b32 s66, s64, 10
    s_add_u32 s65, s65, s66
    s_add_u32 s65, s65, s59
    s_cmp_lt_u32 s62, 162
    s_cselect_b32 s65, s65, 0x40000000
    s_add_u32 s62, s62, 16
    buffer_store_dwordx4 v[48:51], v7, s[24:27], s65 offen sc1
    s_add_u32 s65, s65, 165888
    buffer_store_dwordx4 v[52:55], v7, s[24:27], s65 offen sc1
    s_add_u32 s65, s65, 165888
    buffer_store_dwordx4 v[56:59], v7, s[24:27], s65 offen sc1
    s_add_u32 s65, s65, 165888
    buffer_store_dwordx4 v[60:63], v7, s[24:27], s65 offen sc1
    s_mul_i32 s63, s62, 3641
    s_lshr_b32 s63, s63, 16
    s_mul_i32 s64, s63, 18
    s_sub_u32 s64, s62, s64
    s_mul_i32 s65, s63, 18432
    s_lshl_b32 s66, s64, 10
    s_add_u32 s65, s65, s66
    s_add_u32 s65, s65, s59
    s_cmp_lt_u32 s62, 162
    s_cselect_b32 s65, s65, 0x40000000
    s_add_u32 s62, s62, 16
    buffer_store_dwordx4 v[64:67], v7, s[24:27], s65 offen sc1
    s_add_u32 s65, s65, 165888
    buffer_store_dwordx4 v[68:71], v7, s[24:27], s65 offen sc1
    s_add_u32 s65, s65, 165888
    buffer_store_dwordx4 v[72:75], v7, s[24:27], s65 offen sc1
    s_add_u32 s65, s65, 165888
    buffer_store_dwordx4 v[76:79], v7, s[24:27], s65 offen sc1
    s_sub_u32 s71, s71, 1
    s_cmp_lg_u32 s71, 0
    s_cbranch_scc1 L_attn_tr
    s_waitcnt vmcnt(12)
    ds_read_b64_tr_b16 v[80:81], v20 offset:0
    ds_read_b64_tr_b16 v[82:83], v20 offset:2048
    ds_read_b64_tr_b16 v[84:85], v21 offset:0
    ds_read_b64_tr_b16 v[86:87], v21 offset:2048
    ds_read_b64_tr_b16 v[88:89], v22 offset:0
    ds_read_b64_tr_b16 v[90:91], v22 offset:2048
    ds_read_b64_tr_b16 v[92:93], v23 offset:0
    ds_read_b64_tr_b16 v[94:95], v23 offset:2048
    s_waitcnt lgkmcnt(0)
    buffer_store_dwordx4 v[80:83], v7, s[24:27], s44 offen sc1
    s_add_u32 s44, s44, 165888
    buffer_store_dwordx4 v[84:87], v7, s[24:27], s44 offen sc1
    s_add_u32 s44, s44, 165888
    buffer_store_dwordx4 v[88:91], v7, s[24:27], s44 offen sc1
    s_add_u32 s44, s44, 165888
    buffer_store_dwordx4 v[92:95], v7, s[24:27], s44 offen sc1
    s_waitcnt vmcnt(0)
    s_and_b32 s53, s34, 1
    s_mul_i32 s53, s53, 2654208
    s_lshr_b32 s54, s35, 1
    s_mul_i32 s54, s54, 165888
    s_add_u32 s53, s53, s54
    s_and_b32 s54, s35, 1
    s_lshl_b32 s54, s54, 14
    s_add_u32 s53, s53, s54
    s_add_u32 s54, s53, 26345472
    buffer_load_dword v117, v116, s[24:27], s54 offen
    s_add_u32 s54, s53, 26353664
    buffer_load_dword v117, v116, s[24:27], s54 offen
    s_mul_i32 s52, s35, 20736
    s_add_u32 s54, s52, 36962304
    buffer_load_dword v117, v116, s[24:27], s54 offen
    s_add_u32 s54, s52, 36970496
    buffer_load_dword v117, v116, s[24:27], s54 offen
    s_add_u32 s54, s52, 36978688
    buffer_load_dword v117, v116, s[24:27], s54 offen
    s_waitcnt vmcnt(0)
    s_endpgm
.section .rodata,"a"
.p2align 6
.amdhsa_kernel attn_kernel
  .amdhsa_next_free_vgpr 128
  .amdhsa_next_free_sgpr 102
  .amdhsa_accum_offset 128
  .amdhsa_group_segment_fixed_size 0
  .amdhsa_kernarg_size 104
  .amdhsa_user_sgpr_count 2
  .amdhsa_user_sgpr_kernarg_segment_ptr 1
  .amdhsa_system_sgpr_workgroup_id_x 1
.end_amdhsa_kernel
.text
.globl ffn_kernel
.p2align 8
.type ffn_kernel,@function
ffn_kernel:
    s_cmp_ge_u32 s2, 256
    s_cbranch_scc1 L_ffn_end
    s_load_dwordx2 s[32:33], s[0:1], 96
    s_load_dwordx2 s[4:5], s[0:1], 0
    s_load_dwordx2 s[6:7], s[0:1], 56
    s_load_dwordx4 s[28:31], s[0:1], 72
    s_lshr_b32 s35, s2, 3
    s_and_b32 s34, s2, 1
    s_lshl_b32 s34, s34, 2
    s_and_b32 s41, s35, 3
    s_add_u32 s34, s34, s41
    s_andn2_b32 s36, s35, 3
    s_bfe_u32 s37, s2, 0x20001
    s_add_u32 s36, s36, s37
    v_lshrrev_b32 v1, 6, v0
    v_and_b32 v2, 63, v0
    v_readfirstlane_b32 s38, v1
    v_and_b32 v3, 15, v2
    v_lshrrev_b32 v4, 4, v2
    v_lshlrev_b32 v32, 4, v2
    s_mul_i32 s47, s36, 73728
    s_mul_i32 s48, s38, 18432
    s_and_b32 s49, s41, 1
    s_mul_i32 s49, s49, 9216
    s_add_u32 s50, s48, s49
    s_sub_u32 s51, 9216, s49
    s_add_u32 s51, s51, s48
    s_add_u32 s57, s47, 2752512
    s_mov_b32 s26, 37625856
    s_mov_b32 s27, 0x00020000
    s_and_b32 s74, s34, 1
    s_lshl_b32 s76, s34, 7
    s_lshl_b32 s77, s38, 5
    s_add_u32 s76, s76, s77
    s_add_u32 s78, s77, 1024
    v_lshlrev_b32 v5, 3, v4
    s_waitcnt lgkmcnt(0)
    s_mov_b32 s24, s32
    s_mov_b32 s25, s33
    s_mov_b32 s8, s28
    s_mov_b32 s9, s29
    s_mov_b32 s10, 1152
    s_mov_b32 s11, 0x00020000
    buffer_load_dwordx2 v[16:17], v5, s[8:11], s76 offen
    buffer_load_dwordx2 v[18:19], v5, s[8:11], s78 offen
    s_add_u32 m0, s50, 0
    s_add_u32 s59, m0, s57
    buffer_load_dwordx4 v32, s[24:27], s59 offen offset:0 lds
    buffer_load_dwordx4 v32, s[24:27], s59 offen offset:1024 lds
    buffer_load_dwordx4 v32, s[24:27], s59 offen offset:2048 lds
    buffer_load_dwordx4 v32, s[24:27], s59 offen offset:3072 lds
    s_add_u32 m0, s50, 4096
    s_add_u32 s59, m0, s57
    buffer_load_dwordx4 v32, s[24:27], s59 offen offset:0 lds
    buffer_load_dwordx4 v32, s[24:27], s59 offen offset:1024 lds
    buffer_load_dwordx4 v32, s[24:27], s59 offen offset:2048 lds
    buffer_load_dwordx4 v32, s[24:27], s59 offen offset:3072 lds
    s_add_u32 m0, s50, 8192
    s_add_u32 s59, m0, s57
    buffer_load_dwordx4 v32, s[24:27], s59 offen offset:0 lds
    s_add_u32 m0, s51, 0
    s_add_u32 s59, m0, s57
    buffer_load_dwordx4 v32, s[24:27], s59 offen offset:0 lds
    buffer_load_dwordx4 v32, s[24:27], s59 offen offset:1024 lds
    buffer_load_dwordx4 v32, s[24:27], s59 offen offset:2048 lds
    buffer_load_dwordx4 v32, s[24:27], s59 offen offset:3072 lds
    s_add_u32 m0, s51, 4096
    s_add_u32 s59, m0, s57
    buffer_load_dwordx4 v32, s[24:27], s59 offen offset:0 lds
    buffer_load_dwordx4 v32, s[24:27], s59 offen offset:1024 lds
    buffer_load_dwordx4 v32, s[24:27], s59 offen offset:2048 lds
    buffer_load_dwordx4 v32, s[24:27], s59 offen offset:3072 lds
    s_add_u32 m0, s51, 8192
    s_add_u32 s59, m0, s57
    buffer_load_dwordx4 v32, s[24:27], s59 offen offset:0 lds
    s_lshl_b32 s53, s34, 2
    s_add_u32 s53, s53, s38
    s_mul_i32 s53, s53, 165888
    s_add_u32 s53, s53, 26345472
    s_add_u32 s54, s53, 5308416
    s_mul_i32 s55, s38, 165888
    s_add_u32 s55, s55, 36962304
    s_mul_i32 s43, s34, 18432
    s_add_u32 s43, s43, s55
    s_add_u32 s55, s55, 147456
    buffer_load_dwordx4 a[184:187], v32, s[24:27], s43 offen offset:0
    buffer_load_dwordx4 a[188:191], v32, s[24:27], s43 offen offset:1024
    buffer_load_dwordx4 a[192:195], v32, s[24:27], s43 offen offset:2048
    buffer_load_dwordx4 a[196:199], v32, s[24:27], s43 offen offset:3072
    s_add_u32 s43, s43, 4096
    s_mov_b32 s16, s6
    s_mov_b32 s17, s7
    s_mov_b32 s18, 9216
    s_mov_b32 s19, 0x00020000
    s_mov_b32 s20, s30
    s_mov_b32 s21, s31
    s_mov_b32 s22, 2359296
    s_mov_b32 s23, 0x00020000
    s_mov_b32 s12, s4
    s_mov_b32 s13, s5
    s_mov_b32 s14, 2359296
    s_mov_b32 s15, 0x00020000
    s_lshl_b32 s56, s38, 11
    s_add_u32 s66, s47, s56
    s_lshl_b32 s73, s34, 13
    s_add_u32 s73, s73, s66
    s_lshl_b32 s75, s74, 10
    s_add_u32 s75, s75, s66
    s_add_u32 s75, s75, 65536
    s_add_u32 s76, s76, s47
    s_add_u32 s3, s76, 36864
    s_add_u32 s78, s78, s47
    s_mul_i32 s57, s74, 36864
    s_add_u32 s78, s78, s57
    v_lshrrev_b32 v5, 1, v4
    s_lshl_b32 s57, s38, 1
    v_add_u32 v6, s57, v5
    v_and_b32 v7, 7, v3
    v_xor_b32 v6, v6, v7
    v_lshlrev_b32 v6, 4, v6
    v_lshl_add_u32 v6, v3, 7, v6
    v_and_b32 v7, 1, v4
    v_lshl_add_u32 v6, v7, 3, v6
    v_add_u32 v6, 142336, v6
    v_lshl_add_u32 v7, v7, 4, v3
    v_mul_u32_u24 v23, 1152, v7
    v_lshl_add_u32 v23, v5, 4, v23
    v_add_u32 v33, 36864, v32
    s_lshr_b32 s57, s38, 1
    s_lshl_b32 s57, s57, 11
    s_and_b32 s59, s38, 1
    s_lshl_b32 s59, s59, 3
    s_add_u32 s57, s57, s59
    v_add_u32 v20, s57, v32
    s_lshl_b32 s57, s38, 7
    s_add_u32 s57, s57, 73728
    v_lshl_add_u32 v21, v3, 3, s57
    s_mul_i32 s60, s34, 2359296
    s_add_u32 s60, s60, s66
    s_add_u32 s60, s60, 7471104
    s_mul_i32 s67, s36, 1152
    s_add_u32 s67, s67, s77
    s_add_u32 s67, s67, 2715648
    s_lshl_b32 s57, s34, 2
    s_add_u32 s68, s67, s57
    s_lshl_b32 s69, s34, 7
    s_mov_b32 s63, s69
    s_movk_i32 s71, 1024
    s_mov_b32 s52, s34
    s_lshr_b32 s79, s34, 1
    v_mov_b32 v14, 0
    v_mov_b32 v15, 1
    s_mov_b32 s58, 0xffff0000
    s_mov_b32 s44, 0x3f803f80
    s_lshl_b32 s59, s38, 9
    s_add_u32 s59, s59, 78848
    v_lshl_add_u32 v22, v3, 5, s59
    v_lshrrev_b32 v44, 3, v2
    v_and_b32 v45, 7, v2
    v_xor_b32 v45, v45, v44
    v_mul_u32_u24 v44, 1152, v44
    v_lshl_add_u32 v44, v45, 4, v44
    v_add_u32 v45, 8192, v44
    s_add_u32 s70, s47, s48
    s_lshl_b32 s72, s34, 7
    s_add_u32 s72, s72, s70
    s_add_u32 s70, s70, 1024
    v_min_u32 v46, 143, v0
    v_lshlrev_b32 v47, 3, v46
    v_lshlrev_b32 v46, 4, v46
    s_mul_i32 s64, s34, 2304
    s_add_u32 s65, s64, 18432
    s_add_u32 s42, s64, 36864
    s_mul_i32 s61, s34, 1152
    v_lshlrev_b32 v142, 1, v46
    v_add_u32 v142, 73728, v142
    v_mov_b32 v48, 0
    v_mov_b32 v49, 0
    v_mov_b32 v50, 0
    v_mov_b32 v51, 0
    v_mov_b32 v52, 0
    v_mov_b32 v53, 0
    v_mov_b32 v54, 0
    v_mov_b32 v55, 0
    s_add_u32 m0, s56, 142336
    s_nop 0
    buffer_load_dwordx4 v44, s[12:15], s72 offen lds
    buffer_load_dwordx4 v45, s[12:15], s72 offen offset:1024 lds
    s_add_u32 m0, s56, 150528
    s_nop 0
    buffer_load_dwordx4 v44, s[12:15], s70 offen lds
    buffer_load_dwordx4 v45, s[12:15], s70 offen offset:1024 lds
    buffer_load_dwordx4 v[128:131], v46, s[24:27], s64 offen
    buffer_load_dwordx4 v[132:135], v46, s[24:27], s65 offen
    buffer_load_dwordx4 v[136:139], v46, s[24:27], s42 offen
    buffer_load_dwordx2 v[140:141], v47, s[16:19], s61 offen
    s_waitcnt vmcnt(12)
    s_barrier
    ds_read_b128 a[0:3], v32 offset:0
    ds_read_b128 a[4:7], v32 offset:1024
    ds_read_b128 a[8:11], v33 offset:0
    ds_read_b128 a[12:15], v33 offset:1024
    buffer_load_dwordx4 a[200:203], v32, s[24:27], s43 offen offset:0
    ds_read_b128 a[16:19], v32 offset:2048
    ds_read_b128 a[20:23], v32 offset:3072
    ds_read_b128 a[24:27], v33 offset:2048
    ds_read_b128 a[28:31], v33 offset:3072
    buffer_load_dwordx4 a[204:207], v32, s[24:27], s43 offen offset:1024
    ds_read_b128 a[32:35], v32 offset:4096
    ds_read_b128 a[36:39], v32 offset:5120
    ds_read_b128 a[40:43], v33 offset:4096
    ds_read_b128 a[44:47], v33 offset:5120
    buffer_load_dwordx4 a[208:211], v32, s[24:27], s43 offen offset:2048
    buffer_load_dwordx4 a[212:215], v32, s[24:27], s43 offen offset:3072
    s_add_u32 s43, s43, 4096
    buffer_load_dwordx4 a[216:219], v32, s[24:27], s43 offen offset:0
    buffer_load_dwordx4 a[220:223], v32, s[24:27], s43 offen offset:1024
    buffer_load_dwordx4 a[224:227], v32, s[24:27], s43 offen offset:2048
    buffer_load_dwordx4 a[228:231], v32, s[24:27], s43 offen offset:3072
    s_add_u32 s43, s43, 4096
    buffer_load_dwordx4 a[232:235], v32, s[24:27], s43 offen offset:0
    buffer_load_dwordx4 a[236:239], v32, s[24:27], s43 offen offset:1024
    buffer_load_dwordx4 a[240:243], v32, s[24:27], s43 offen offset:2048
    buffer_load_dwordx4 a[244:247], v32, s[24:27], s43 offen offset:3072
    s_add_u32 s43, s43, 4096
    buffer_load_dwordx4 a[248:251], v32, s[24:27], s43 offen offset:0
    s_waitcnt vmcnt(16)
    s_waitcnt lgkmcnt(8)
    v_mfma_f32_16x16x32_bf16 v[80:83], a[184:187], a[0:3], 0
    buffer_load_dwordx4 a[252:255], v32, s[24:27], s43 offen offset:1024
    s_mov_b32 s43, s55
    v_mfma_f32_16x16x32_bf16 v[84:87], a[184:187], a[4:7], 0
    ds_read_b128 a[48:51], v32 offset:6144
    ds_read_b128 a[52:55], v32 offset:7168
    v_mfma_f32_16x16x32_bf16 v[88:91], a[184:187], a[8:11], 0
    ds_read_b128 a[56:59], v33 offset:6144
    ds_read_b128 a[60:63], v33 offset:7168
    v_mfma_f32_16x16x32_bf16 v[92:95], a[184:187], a[12:15], 0
    s_waitcnt vmcnt(16)
    s_waitcnt lgkmcnt(8)
    v_mfma_f32_16x16x32_bf16 v[80:83], a[188:191], a[16:19], v[80:83]
    buffer_load_dwordx4 a[184:187], v32, s[24:27], s43 offen offset:0
    v_mfma_f32_16x16x32_bf16 v[84:87], a[188:191], a[20:23], v[84:87]
    ds_read_b128 a[64:67], v32 offset:8192
    ds_read_b128 a[68:71], v32 offset:9216
    v_mfma_f32_16x16x32_bf16 v[88:91], a[188:191], a[24:27], v[88:91]
    ds_read_b128 a[72:75], v33 offset:8192
    ds_read_b128 a[76:79], v33 offset:9216
    v_mfma_f32_16x16x32_bf16 v[92:95], a[188:191], a[28:31], v[92:95]
    s_waitcnt vmcnt(16)
    s_waitcnt lgkmcnt(8)
    v_mfma_f32_16x16x32_bf16 v[80:83], a[192:195], a[32:35], v[80:83]
    buffer_load_dwordx4 a[188:191], v32, s[24:27], s43 offen offset:1024
    v_mfma_f32_16x16x32_bf16 v[84:87], a[192:195], a[36:39], v[84:87]
    ds_read_b128 a[80:83], v32 offset:10240
    ds_read_b128 a[84:87], v32 offset:11264
    v_mfma_f32_16x16x32_bf16 v[88:91], a[192:195], a[40:43], v[88:91]
    ds_read_b128 a[88:91], v33 offset:10240
    ds_read_b128 a[92:95], v33 offset:11264
    v_mfma_f32_16x16x32_bf16 v[92:95], a[192:195], a[44:47], v[92:95]
    s_mov_b32 s55, s53
    s_waitcnt vmcnt(16)
    s_waitcnt lgkmcnt(8)
    v_mfma_f32_16x16x32_bf16 v[80:83], a[196:199], a[48:51], v[80:83]
    buffer_load_dwordx4 a[192:195], v32, s[24:27], s43 offen offset:2048
    v_mfma_f32_16x16x32_bf16 v[84:87], a[196:199], a[52:55], v[84:87]
    ds_read_b128 a[96:99], v32 offset:12288
    ds_read_b128 a[100:103], v32 offset:13312
    v_mfma_f32_16x16x32_bf16 v[88:91], a[196:199], a[56:59], v[88:91]
    ds_read_b128 a[104:107], v33 offset:12288
    ds_read_b128 a[108:111], v33 offset:13312
    v_mfma_f32_16x16x32_bf16 v[92:95], a[196:199], a[60:63], v[92:95]
    s_waitcnt vmcnt(16)
    s_waitcnt lgkmcnt(8)
    v_mfma_f32_16x16x32_bf16 v[80:83], a[200:203], a[64:67], v[80:83]
    buffer_load_dwordx4 a[196:199], v32, s[24:27], s43 offen offset:3072
    s_add_u32 s43, s43, 4096
    v_mfma_f32_16x16x32_bf16 v[84:87], a[200:203], a[68:71], v[84:87]
    ds_read_b128 a[112:115], v32 offset:14336
    ds_read_b128 a[116:119], v32 offset:15360
    v_mfma_f32_16x16x32_bf16 v[88:91], a[200:203], a[72:75], v[88:91]
    ds_read_b128 a[120:123], v33 offset:14336
    ds_read_b128 a[124:127], v33 offset:15360
    v_mfma_f32_16x16x32_bf16 v[92:95], a[200:203], a[76:79], v[92:95]
    s_waitcnt vmcnt(16)
    s_waitcnt lgkmcnt(8)
    v_mfma_f32_16x16x32_bf16 v[80:83], a[204:207], a[80:83], v[80:83]
    buffer_load_dwordx4 a[200:203], v32, s[24:27], s43 offen offset:0
    v_mfma_f32_16x16x32_bf16 v[84:87], a[204:207], a[84:87], v[84:87]
    ds_read_b128 a[128:131], v32 offset:16384
    ds_read_b128 a[132:135], v32 offset:17408
    v_mfma_f32_16x16x32_bf16 v[88:91], a[204:207], a[88:91], v[88:91]
    ds_read_b128 a[136:139], v33 offset:16384
    ds_read_b128 a[140:143], v33 offset:17408
    v_mfma_f32_16x16x32_bf16 v[92:95], a[204:207], a[92:95], v[92:95]
    s_waitcnt vmcnt(16)
    s_waitcnt lgkmcnt(8)
    v_mfma_f32_16x16x32_bf16 v[80:83], a[208:211], a[96:99], v[80:83]
    buffer_load_dwordx4 a[204:207], v32, s[24:27], s43 offen offset:1024
    v_mfma_f32_16x16x32_bf16 v[84:87], a[208:211], a[100:103], v[84:87]
    ds_read_b128 a[144:147], v32 offset:18432
    ds_read_b128 a[148:151], v32 offset:19456
    v_mfma_f32_16x16x32_bf16 v[88:91], a[208:211], a[104:107], v[88:91]
    ds_read_b128 a[152:155], v33 offset:18432
    ds_read_b128 a[156:159], v33 offset:19456
    v_mfma_f32_16x16x32_bf16 v[92:95], a[208:211], a[108:111], v[92:95]
    s_waitcnt vmcnt(16)
    s_waitcnt lgkmcnt(8)
    v_mfma_f32_16x16x32_bf16 v[80:83], a[212:215], a[112:115], v[80:83]
    buffer_load_dwordx4 a[208:211], v32, s[24:27], s43 offen offset:2048
    v_mfma_f32_16x16x32_bf16 v[84:87], a[212:215], a[116:119], v[84:87]
    ds_read_b128 a[160:163], v32 offset:20480
    ds_read_b128 a[164:167], v32 offset:21504
    v_mfma_f32_16x16x32_bf16 v[88:91], a[212:215], a[120:123], v[88:91]
    ds_read_b128 a[168:171], v33 offset:20480
    ds_read_b128 a[172:175], v33 offset:21504
    v_mfma_f32_16x16x32_bf16 v[92:95], a[212:215], a[124:127], v[92:95]
    s_waitcnt vmcnt(16)
    s_waitcnt lgkmcnt(8)
    v_mfma_f32_16x16x32_bf16 v[80:83], a[216:219], a[128:131], v[80:83]
    buffer_load_dwordx4 a[212:215], v32, s[24:27], s43 offen offset:3072
    s_add_u32 s43, s43, 4096
    v_mfma_f32_16x16x32_bf16 v[84:87], a[216:219], a[132:135], v[84:87]
    ds_read_b128 a[176:179], v32 offset:22528
    ds_read_b128 a[180:183], v32 offset:23552
    v_mfma_f32_16x16x32_bf16 v[88:91], a[216:219], a[136:139], v[88:91]
    ds_read_b128 v[152:155], v33 offset:22528
    ds_read_b128 v[156:159], v33 offset:23552
    v_mfma_f32_16x16x32_bf16 v[92:95], a[216:219], a[140:143], v[92:95]
    s_waitcnt vmcnt(16)
    s_waitcnt lgkmcnt(8)
    v_mfma_f32_16x16x32_bf16 v[80:83], a[220:223], a[144:147], v[80:83]
    buffer_load_dwordx4 a[216:219], v32, s[24:27], s43 offen offset:0
    v_mfma_f32_16x16x32_bf16 v[84:87], a[220:223], a[148:151], v[84:87]
    ds_read_b128 v[160:163], v32 offset:24576
    ds_read_b128 v[164:167], v32 offset:25600
    v_mfma_f32_16x16x32_bf16 v[88:91], a[220:223], a[152:155], v[88:91]
    ds_read_b128 v[168:171], v33 offset:24576
    ds_read_b128 v[172:175], v33 offset:25600
    v_mfma_f32_16x16x32_bf16 v[92:95], a[220:223], a[156:159], v[92:95]
    s_waitcnt vmcnt(16)
    s_waitcnt lgkmcnt(8)
    v_mfma_f32_16x16x32_bf16 v[80:83], a[224:227], a[160:163], v[80:83]
    buffer_load_dwordx4 a[220:223], v32, s[24:27], s43 offen offset:1024
    v_mfma_f32_16x16x32_bf16 v[84:87], a[224:227], a[164:167], v[84:87]
    ds_read_b128 v[176:179], v32 offset:26624
    ds_read_b128 v[180:183], v32 offset:27648
    v_mfma_f32_16x16x32_bf16 v[88:91], a[224:227], a[168:171], v[88:91]
    ds_read_b128 v[184:187], v33 offset:26624
    ds_read_b128 v[188:191], v33 offset:27648
    v_mfma_f32_16x16x32_bf16 v[92:95], a[224:227], a[172:175], v[92:95]
    s_waitcnt vmcnt(16)
    s_waitcnt lgkmcnt(8)
    v_mfma_f32_16x16x32_bf16 v[80:83], a[228:231], a[176:179], v[80:83]
    buffer_load_dwordx4 a[224:227], v32, s[24:27], s43 offen offset:2048
    v_mfma_f32_16x16x32_bf16 v[84:87], a[228:231], a[180:183], v[84:87]
    ds_read_b128 v[192:195], v32 offset:28672
    ds_read_b128 v[196:199], v32 offset:29696
    v_mfma_f32_16x16x32_bf16 v[88:91], a[228:231], v[152:155], v[88:91]
    ds_read_b128 v[200:203], v33 offset:28672
    ds_read_b128 v[204:207], v33 offset:29696
    v_mfma_f32_16x16x32_bf16 v[92:95], a[228:231], v[156:159], v[92:95]
    s_waitcnt vmcnt(16)
    s_waitcnt lgkmcnt(8)
    v_mfma_f32_16x16x32_bf16 v[80:83], a[232:235], v[160:163], v[80:83]
    buffer_load_dwordx4 a[228:231], v32, s[24:27], s43 offen offset:3072
    s_add_u32 s43, s43, 4096
    v_mfma_f32_16x16x32_bf16 v[84:87], a[232:235], v[164:167], v[84:87]
    ds_read_b128 v[208:211], v32 offset:30720
    ds_read_b128 v[212:215], v32 offset:31744
    v_mfma_f32_16x16x32_bf16 v[88:91], a[232:235], v[168:171], v[88:91]
    ds_read_b128 v[216:219], v33 offset:30720
    ds_read_b128 v[220:223], v33 offset:31744
    v_mfma_f32_16x16x32_bf16 v[92:95], a[232:235], v[172:175], v[92:95]
    s_waitcnt vmcnt(16)
    s_waitcnt lgkmcnt(8)
    v_mfma_f32_16x16x32_bf16 v[80:83], a[236:239], v[176:179], v[80:83]
    buffer_load_dwordx4 a[232:235], v32, s[24:27], s43 offen offset:0
    v_mfma_f32_16x16x32_bf16 v[84:87], a[236:239], v[180:183], v[84:87]
    ds_read_b128 v[224:227], v32 offset:32768
    ds_read_b128 v[228:231], v32 offset:33792
    v_mfma_f32_16x16x32_bf16 v[88:91], a[236:239], v[184:187], v[88:91]
    ds_read_b128 v[232:235], v33 offset:32768
    ds_read_b128 v[236:239], v33 offset:33792
    v_mfma_f32_16x16x32_bf16 v[92:95], a[236:239], v[188:191], v[92:95]
    s_waitcnt vmcnt(16)
    s_waitcnt lgkmcnt(8)
    v_mfma_f32_16x16x32_bf16 v[80:83], a[240:243], v[192:195], v[80:83]
    buffer_load_dwordx4 a[236:239], v32, s[24:27], s43 offen offset:1024
    v_mfma_f32_16x16x32_bf16 v[84:87], a[240:243], v[196:199], v[84:87]
    ds_read_b128 v[240:243], v32 offset:34816
    ds_read_b128 v[244:247], v32 offset:35840
    v_mfma_f32_16x16x32_bf16 v[88:91], a[240:243], v[200:203], v[88:91]
    ds_read_b128 v[248:251], v33 offset:34816
    ds_read_b128 v[252:255], v33 offset:35840
    v_mfma_f32_16x16x32_bf16 v[92:95], a[240:243], v[204:207], v[92:95]
    s_waitcnt vmcnt(16)
    s_waitcnt lgkmcnt(8)
    v_mfma_f32_16x16x32_bf16 v[80:83], a[244:247], v[208:211], v[80:83]
    buffer_load_dwordx4 a[240:243], v32, s[24:27], s43 offen offset:2048
    v_mfma_f32_16x16x32_bf16 v[84:87], a[244:247], v[212:215], v[84:87]
    v_mfma_f32_16x16x32_bf16 v[88:91], a[244:247], v[216:219], v[88:91]
    v_mfma_f32_16x16x32_bf16 v[92:95], a[244:247], v[220:223], v[92:95]
    s_waitcnt vmcnt(16)
    s_waitcnt lgkmcnt(4)
    v_mfma_f32_16x16x32_bf16 v[80:83], a[248:251], v[224:227], v[80:83]
    buffer_load_dwordx4 a[244:247], v32, s[24:27], s43 offen offset:3072
    s_add_u32 s43, s43, 4096
    v_mfma_f32_16x16x32_bf16 v[84:87], a[248:251], v[228:231], v[84:87]
    s_waitcnt lgkmcnt(0)
    s_barrier
    v_mfma_f32_16x16x32_bf16 v[88:91], a[248:251], v[232:235], v[88:91]
    v_mfma_f32_16x16x32_bf16 v[92:95], a[248:251], v[236:239], v[92:95]
    s_waitcnt vmcnt(16)
    v_mfma_f32_16x16x32_bf16 v[80:83], a[252:255], v[240:243], v[80:83]
    buffer_load_dwordx4 a[248:251], v32, s[24:27], s43 offen offset:0
    ds_read_b64 v[112:113], v6 offset:0
    v_mfma_f32_16x16x32_bf16 v[84:87], a[252:255], v[244:247], v[84:87]
    ds_read_b64 v[114:115], v6 offset:2048
    ds_read_b64 v[116:117], v6 offset:4096
    ds_read_b64 v[118:119], v6 offset:6144
    v_mfma_f32_16x16x32_bf16 v[88:91], a[252:255], v[248:251], v[88:91]
    ds_read_b64 v[120:121], v6 offset:8192
    ds_read_b64 v[122:123], v6 offset:10240
    ds_read_b64 v[124:125], v6 offset:12288
    v_mfma_f32_16x16x32_bf16 v[92:95], a[252:255], v[252:255], v[92:95]
    ds_read_b64 v[126:127], v6 offset:14336
    s_waitcnt vmcnt(16)
    v_mfma_f32_16x16x32_bf16 v[96:99], a[184:187], a[0:3], 0
    buffer_load_dwordx4 a[252:255], v32, s[24:27], s43 offen offset:1024
    s_mov_b32 s43, s55
    v_mfma_f32_16x16x32_bf16 v[100:103], a[184:187], a[4:7], 0
    v_mfma_f32_16x16x32_bf16 v[104:107], a[184:187], a[8:11], 0
    v_mfma_f32_16x16x32_bf16 v[108:111], a[184:187], a[12:15], 0
    s_waitcnt vmcnt(16)
    v_mfma_f32_16x16x32_bf16 v[96:99], a[188:191], a[16:19], v[96:99]
    buffer_load_dwordx4 a[184:187], v32, s[24:27], s43 offen offset:0
    s_waitcnt lgkmcnt(0)
    v_mfma_f32_16x16x32_bf16 v[100:103], a[188:191], a[20:23], v[100:103]
    v_lshlrev_b32 v44, 16, v112
    v_and_b32 v45, s58, v112
    v_add_f32 v80, v80, v44
    v_add_f32 v81, v81, v45
    v_mfma_f32_16x16x32_bf16 v[104:107], a[188:191], a[24:27], v[104:107]
    v_cvt_pk_bf16_f32 v24, v80, v81
    v_lshlrev_b32 v44, 16, v113
    v_and_b32 v45, s58, v113
    v_add_f32 v82, v82, v44
    v_mfma_f32_16x16x32_bf16 v[108:111], a[188:191], a[28:31], v[108:111]
    v_add_f32 v83, v83, v45
    v_cvt_pk_bf16_f32 v25, v82, v83
    s_waitcnt vmcnt(16)
    v_mfma_f32_16x16x32_bf16 v[96:99], a[192:195], a[32:35], v[96:99]
    buffer_load_dwordx4 a[188:191], v32, s[24:27], s43 offen offset:1024
    s_add_u32 s55, s53, 18432
    v_mfma_f32_16x16x32_bf16 v[100:103], a[192:195], a[36:39], v[100:103]
    v_lshlrev_b32 v44, 16, v114
    v_and_b32 v45, s58, v114
    v_add_f32 v84, v84, v44
    v_add_f32 v85, v85, v45
    v_mfma_f32_16x16x32_bf16 v[104:107], a[192:195], a[40:43], v[104:107]
    v_cvt_pk_bf16_f32 v26, v84, v85
    v_lshlrev_b32 v44, 16, v115
    v_and_b32 v45, s58, v115
    v_add_f32 v86, v86, v44
    v_mfma_f32_16x16x32_bf16 v[108:111], a[192:195], a[44:47], v[108:111]
    v_add_f32 v87, v87, v45
    v_cvt_pk_bf16_f32 v27, v86, v87
    s_waitcnt vmcnt(16)
    v_mfma_f32_16x16x32_bf16 v[96:99], a[196:199], a[48:51], v[96:99]
    buffer_load_dwordx4 a[192:195], v32, s[24:27], s43 offen offset:2048
    v_lshlrev_b32 v44, 16, v116
    v_mfma_f32_16x16x32_bf16 v[100:103], a[196:199], a[52:55], v[100:103]
    v_and_b32 v45, s58, v116
    v_add_f32 v88, v88, v44
    v_add_f32 v89, v89, v45
    v_cvt_pk_bf16_f32 v28, v88, v89
    v_mfma_f32_16x16x32_bf16 v[104:107], a[196:199], a[56:59], v[104:107]
    v_lshlrev_b32 v44, 16, v117
    v_and_b32 v45, s58, v117
    v_add_f32 v90, v90, v44
    v_add_f32 v91, v91, v45
    v_mfma_f32_16x16x32_bf16 v[108:111], a[196:199], a[60:63], v[108:111]
    v_cvt_pk_bf16_f32 v29, v90, v91
    s_waitcnt vmcnt(16)
    v_mfma_f32_16x16x32_bf16 v[96:99], a[200:203], a[64:67], v[96:99]
    buffer_load_dwordx4 a[196:199], v32, s[24:27], s43 offen offset:3072
    s_add_u32 s43, s43, 4096
    v_lshlrev_b32 v44, 16, v118
    v_mfma_f32_16x16x32_bf16 v[100:103], a[200:203], a[68:71], v[100:103]
    v_and_b32 v45, s58, v118
    v_add_f32 v92, v92, v44
    v_add_f32 v93, v93, v45
    v_cvt_pk_bf16_f32 v30, v92, v93
    v_mfma_f32_16x16x32_bf16 v[104:107], a[200:203], a[72:75], v[104:107]
    v_lshlrev_b32 v44, 16, v119
    v_and_b32 v45, s58, v119
    v_add_f32 v94, v94, v44
    v_add_f32 v95, v95, v45
    v_mfma_f32_16x16x32_bf16 v[108:111], a[200:203], a[76:79], v[108:111]
    v_cvt_pk_bf16_f32 v31, v94, v95
    s_waitcnt vmcnt(16)
    v_mfma_f32_16x16x32_bf16 v[96:99], a[204:207], a[80:83], v[96:99]
    buffer_load_dwordx4 a[200:203], v32, s[24:27], s43 offen offset:0
    v_mfma_f32_16x16x32_bf16 v[100:103], a[204:207], a[84:87], v[100:103]
    s_add_u32 s72, s73, 5111808
    buffer_store_dwordx4 v[24:27], v32, s[24:27], s72 offen sc1
    buffer_store_dwordx4 v[28:31], v32, s[24:27], s72 offen offset:1024 sc1
    v_mfma_f32_16x16x32_bf16 v[104:107], a[204:207], a[88:91], v[104:107]
    v_mfma_f32_16x16x32_bf16 v[108:111], a[204:207], a[92:95], v[108:111]
    s_waitcnt vmcnt(16)
    v_mfma_f32_16x16x32_bf16 v[96:99], a[208:211], a[96:99], v[96:99]
    buffer_load_dwordx4 a[204:207], v32, s[24:27], s43 offen offset:1024
    v_mfma_f32_16x16x32_bf16 v[100:103], a[208:211], a[100:103], v[100:103]
    v_mfma_f32_16x16x32_bf16 v[104:107], a[208:211], a[104:107], v[104:107]
    v_mfma_f32_16x16x32_bf16 v[108:111], a[208:211], a[108:111], v[108:111]
    s_waitcnt vmcnt(16)
    v_mfma_f32_16x16x32_bf16 v[96:99], a[212:215], a[112:115], v[96:99]
    buffer_load_dwordx4 a[208:211], v32, s[24:27], s43 offen offset:2048
    v_mfma_f32_16x16x32_bf16 v[100:103], a[212:215], a[116:119], v[100:103]
    s_add_u32 s57, s34, 0
    s_and_b32 s57, s57, 7
    s_lshl_b32 s57, s57, 12
    v_add_u32 v1, s57, v20
    ds_write_b64 v1, v[24:25] offset:0
    ds_write_b64 v1, v[26:27] offset:1024
    ds_write_b64 v1, v[28:29] offset:36864
    ds_write_b64 v1, v[30:31] offset:37888
    v_mfma_f32_16x16x32_bf16 v[104:107], a[212:215], a[120:123], v[104:107]
    v_mfma_f32_16x16x32_bf16 v[108:111], a[212:215], a[124:127], v[108:111]
    s_waitcnt vmcnt(16)
    v_mfma_f32_16x16x32_bf16 v[96:99], a[216:219], a[128:131], v[96:99]
    buffer_load_dwordx4 a[212:215], v32, s[24:27], s43 offen offset:3072
    s_add_u32 s43, s43, 4096
    v_mfma_f32_16x16x32_bf16 v[100:103], a[216:219], a[132:135], v[100:103]
    v_mfma_f32_16x16x32_bf16 v[104:107], a[216:219], a[136:139], v[104:107]
    v_mfma_f32_16x16x32_bf16 v[108:111], a[216:219], a[140:143], v[108:111]
    s_waitcnt vmcnt(16)
    v_mfma_f32_16x16x32_bf16 v[96:99], a[220:223], a[144:147], v[96:99]
    buffer_load_dwordx4 a[216:219], v32, s[24:27], s43 offen offset:0
    v_mfma_f32_16x16x32_bf16 v[100:103], a[220:223], a[148:151], v[100:103]
    v_mfma_f32_16x16x32_bf16 v[104:107], a[220:223], a[152:155], v[104:107]
    v_mfma_f32_16x16x32_bf16 v[108:111], a[220:223], a[156:159], v[108:111]
    s_waitcnt vmcnt(16)
    v_mfma_f32_16x16x32_bf16 v[96:99], a[224:227], a[160:163], v[96:99]
    buffer_load_dwordx4 a[220:223], v32, s[24:27], s43 offen offset:1024
    v_mfma_f32_16x16x32_bf16 v[100:103], a[224:227], a[164:167], v[100:103]
    v_add_f32 v128, v128, v132
    v_add_f32 v128, v128, v136
    v_and_b32 v132, s58, v128
    v_sub_f32 v128, v128, v132
    v_cvt_pk_bf16_f32 v144, v132, v128
    v_lshrrev_b32 v132, 16, v132
    v_lshl_or_b32 v145, v140, 16, v132
    v_add_f32 v129, v129, v133
    v_add_f32 v129, v129, v137
    v_and_b32 v133, s58, v129
    v_sub_f32 v129, v129, v133
    v_cvt_pk_bf16_f32 v146, v133, v129
    v_lshrrev_b32 v133, 16, v133
    v_and_or_b32 v147, v140, s58, v133
    v_add_f32 v130, v130, v134
    v_add_f32 v130, v130, v138
    v_and_b32 v134, s58, v130
    v_sub_f32 v130, v130, v134
    v_cvt_pk_bf16_f32 v148, v134, v130
    v_lshrrev_b32 v134, 16, v134
    v_lshl_or_b32 v149, v141, 16, v134
    v_add_f32 v131, v131, v135
    v_add_f32 v131, v131, v139
    v_and_b32 v135, s58, v131
    v_sub_f32 v131, v131, v135
    v_cvt_pk_bf16_f32 v150, v135, v131
    v_lshrrev_b32 v135, 16, v135
    v_and_or_b32 v151, v141, s58, v135
    ds_write_b128 v142, v[144:147]
    ds_write_b128 v142, v[148:151] offset:16
    v_mfma_f32_16x16x32_bf16 v[104:107], a[224:227], a[168:171], v[104:107]
    v_mfma_f32_16x16x32_bf16 v[108:111], a[224:227], a[172:175], v[108:111]
    s_waitcnt vmcnt(16)
    v_mfma_f32_16x16x32_bf16 v[96:99], a[228:231], a[176:179], v[96:99]
    buffer_load_dwordx4 a[224:227], v32, s[24:27], s43 offen offset:2048
    v_mfma_f32_16x16x32_bf16 v[100:103], a[228:231], a[180:183], v[100:103]
    v_mfma_f32_16x16x32_bf16 v[104:107], a[228:231], v[152:155], v[104:107]
    v_mfma_f32_16x16x32_bf16 v[108:111], a[228:231], v[156:159], v[108:111]
    s_waitcnt vmcnt(16)
    v_mfma_f32_16x16x32_bf16 v[96:99], a[232:235], v[160:163], v[96:99]
    buffer_load_dwordx4 a[228:231], v32, s[24:27], s43 offen offset:3072
    s_add_u32 s43, s43, 4096
    v_mfma_f32_16x16x32_bf16 v[100:103], a[232:235], v[164:167], v[100:103]
    v_mfma_f32_16x16x32_bf16 v[104:107], a[232:235], v[168:171], v[104:107]
    v_mfma_f32_16x16x32_bf16 v[108:111], a[232:235], v[172:175], v[108:111]
    s_waitcnt vmcnt(16)
    v_mfma_f32_16x16x32_bf16 v[96:99], a[236:239], v[176:179], v[96:99]
    buffer_load_dwordx4 a[232:235], v32, s[24:27], s43 offen offset:0
    v_mfma_f32_16x16x32_bf16 v[100:103], a[236:239], v[180:183], v[100:103]
    v_mfma_f32_16x16x32_bf16 v[104:107], a[236:239], v[184:187], v[104:107]
    v_mfma_f32_16x16x32_bf16 v[108:111], a[236:239], v[188:191], v[108:111]
    s_waitcnt vmcnt(16)
    v_mfma_f32_16x16x32_bf16 v[96:99], a[240:243], v[192:195], v[96:99]
    buffer_load_dwordx4 a[236:239], v32, s[24:27], s43 offen offset:1024
    v_mfma_f32_16x16x32_bf16 v[100:103], a[240:243], v[196:199], v[100:103]
    v_dot2c_f32_bf16 v48, s44, v24
    v_dot2c_f32_bf16 v49, v24, v24
    v_dot2c_f32_bf16 v50, s44, v26
    v_dot2c_f32_bf16 v51, v26, v26
    v_dot2c_f32_bf16 v52, s44, v28
    v_dot2c_f32_bf16 v53, v28, v28
    v_dot2c_f32_bf16 v54, s44, v30
    v_dot2c_f32_bf16 v55, v30, v30
    v_dot2c_f32_bf16 v48, s44, v25
    v_dot2c_f32_bf16 v49, v25, v25
    v_dot2c_f32_bf16 v50, s44, v27
    v_dot2c_f32_bf16 v51, v27, v27
    v_dot2c_f32_bf16 v52, s44, v29
    v_dot2c_f32_bf16 v53, v29, v29
    v_dot2c_f32_bf16 v54, s44, v31
    v_dot2c_f32_bf16 v55, v31, v31
    v_mfma_f32_16x16x32_bf16 v[104:107], a[240:243], v[200:203], v[104:107]
    v_mfma_f32_16x16x32_bf16 v[108:111], a[240:243], v[204:207], v[108:111]
    s_waitcnt vmcnt(16)
    v_mfma_f32_16x16x32_bf16 v[96:99], a[244:247], v[208:211], v[96:99]
    buffer_load_dwordx4 a[240:243], v32, s[24:27], s43 offen offset:2048
    v_mfma_f32_16x16x32_bf16 v[100:103], a[244:247], v[212:215], v[100:103]
    v_mfma_f32_16x16x32_bf16 v[104:107], a[244:247], v[216:219], v[104:107]
    v_mfma_f32_16x16x32_bf16 v[108:111], a[244:247], v[220:223], v[108:111]
    s_waitcnt vmcnt(16)
    v_mfma_f32_16x16x32_bf16 v[96:99], a[248:251], v[224:227], v[96:99]
    buffer_load_dwordx4 a[244:247], v32, s[24:27], s43 offen offset:3072
    s_add_u32 s43, s43, 4096
    v_mfma_f32_16x16x32_bf16 v[100:103], a[248:251], v[228:231], v[100:103]
    v_mfma_f32_16x16x32_bf16 v[104:107], a[248:251], v[232:235], v[104:107]
    v_mfma_f32_16x16x32_bf16 v[108:111], a[248:251], v[236:239], v[108:111]
    s_waitcnt vmcnt(16)
    v_mfma_f32_16x16x32_bf16 v[96:99], a[252:255], v[240:243], v[96:99]
    buffer_load_dwordx4 a[248:251], v32, s[24:27], s43 offen offset:0
    v_mfma_f32_16x16x32_bf16 v[100:103], a[252:255], v[244:247], v[100:103]
    v_mfma_f32_16x16x32_bf16 v[104:107], a[252:255], v[248:251], v[104:107]
    v_mfma_f32_16x16x32_bf16 v[108:111], a[252:255], v[252:255], v[108:111]
    s_add_u32 s57, s34, 1
    s_and_b32 s57, s57, 7
    s_lshl_b32 s57, s57, 13
    s_add_u32 s57, s57, s66
    s_add_u32 s57, s57, 5111808
    buffer_load_dwordx4 v[160:163], v32, s[24:27], s57 offen sc1
    buffer_load_dwordx4 v[164:167], v32, s[24:27], s57 offen offset:1024 sc1
    s_add_u32 s57, s34, 2
    s_and_b32 s57, s57, 7
    s_lshl_b32 s57, s57, 13
    s_add_u32 s57, s57, s66
    s_add_u32 s57, s57, 5111808
    buffer_load_dwordx4 v[168:171], v32, s[24:27], s57 offen sc1
    buffer_load_dwordx4 v[172:175], v32, s[24:27], s57 offen offset:1024 sc1
    s_add_u32 s57, s34, 3
    s_and_b32 s57, s57, 7
    s_lshl_b32 s57, s57, 13
    s_add_u32 s57, s57, s66
    s_add_u32 s57, s57, 5111808
    buffer_load_dwordx4 v[176:179], v32, s[24:27], s57 offen sc1
    buffer_load_dwordx4 v[180:183], v32, s[24:27], s57 offen offset:1024 sc1
    s_add_u32 s57, s34, 4
    s_and_b32 s57, s57, 7
    s_lshl_b32 s57, s57, 13
    s_add_u32 s57, s57, s66
    s_add_u32 s57, s57, 5111808
    buffer_load_dwordx4 v[184:187], v32, s[24:27], s57 offen sc1
    buffer_load_dwordx4 v[188:191], v32, s[24:27], s57 offen offset:1024 sc1
    s_add_u32 s57, s34, 5
    s_and_b32 s57, s57, 7
    s_lshl_b32 s57, s57, 13
    s_add_u32 s57, s57, s66
    s_add_u32 s57, s57, 5111808
    buffer_load_dwordx4 v[192:195], v32, s[24:27], s57 offen sc1
    buffer_load_dwordx4 v[196:199], v32, s[24:27], s57 offen offset:1024 sc1
    s_add_u32 s57, s34, 6
    s_and_b32 s57, s57, 7
    s_lshl_b32 s57, s57, 13
    s_add_u32 s57, s57, s66
    s_add_u32 s57, s57, 5111808
    buffer_load_dwordx4 v[200:203], v32, s[24:27], s57 offen sc1
    buffer_load_dwordx4 v[204:207], v32, s[24:27], s57 offen offset:1024 sc1
    s_add_u32 s57, s34, 7
    s_and_b32 s57, s57, 7
    s_lshl_b32 s57, s57, 13
    s_add_u32 s57, s57, s66
    s_add_u32 s57, s57, 5111808
    buffer_load_dwordx4 v[208:211], v32, s[24:27], s57 offen sc1
    buffer_load_dwordx4 v[212:215], v32, s[24:27], s57 offen offset:1024 sc1
    s_mul_i32 s64, s34, 18432
    s_add_u32 s64, s64, s54
    s_lshl_b32 s65, s38, 10
    v_lshlrev_b32 v44, 16, v120
    v_and_b32 v45, s58, v120
    v_add_f32 v96, v96, v44
    v_add_f32 v97, v97, v45
    v_cvt_pk_bf16_f32 v152, v96, v97
    v_lshlrev_b32 v44, 16, v121
    v_and_b32 v45, s58, v121
    v_add_f32 v98, v98, v44
    v_add_f32 v99, v99, v45
    v_cvt_pk_bf16_f32 v153, v98, v99
    v_lshlrev_b32 v44, 16, v122
    v_and_b32 v45, s58, v122
    v_add_f32 v100, v100, v44
    v_add_f32 v101, v101, v45
    v_cvt_pk_bf16_f32 v154, v100, v101
    v_lshlrev_b32 v44, 16, v123
    v_and_b32 v45, s58, v123
    v_add_f32 v102, v102, v44
    v_add_f32 v103, v103, v45
    v_cvt_pk_bf16_f32 v155, v102, v103
    v_lshlrev_b32 v44, 16, v124
    v_and_b32 v45, s58, v124
    v_add_f32 v104, v104, v44
    v_add_f32 v105, v105, v45
    v_cvt_pk_bf16_f32 v156, v104, v105
    v_lshlrev_b32 v44, 16, v125
    v_and_b32 v45, s58, v125
    v_add_f32 v106, v106, v44
    v_add_f32 v107, v107, v45
    v_cvt_pk_bf16_f32 v157, v106, v107
    v_lshlrev_b32 v44, 16, v126
    v_and_b32 v45, s58, v126
    v_add_f32 v108, v108, v44
    v_add_f32 v109, v109, v45
    v_cvt_pk_bf16_f32 v158, v108, v109
    v_lshlrev_b32 v44, 16, v127
    v_and_b32 v45, s58, v127
    v_add_f32 v110, v110, v44
    v_add_f32 v111, v111, v45
    v_cvt_pk_bf16_f32 v159, v110, v111
    v_add_u32 v1, 32768, v20
    ds_write_b64 v1, v[152:153] offset:0
    ds_write_b64 v1, v[154:155] offset:1024
    ds_write_b64 v1, v[156:157] offset:36864
    ds_write_b64 v1, v[158:159] offset:37888
    v_dot2c_f32_bf16 v48, s44, v152
    v_dot2c_f32_bf16 v49, v152, v152
    v_dot2c_f32_bf16 v50, s44, v154
    v_dot2c_f32_bf16 v51, v154, v154
    v_dot2c_f32_bf16 v52, s44, v156
    v_dot2c_f32_bf16 v53, v156, v156
    v_dot2c_f32_bf16 v54, s44, v158
    v_dot2c_f32_bf16 v55, v158, v158
    v_dot2c_f32_bf16 v48, s44, v153
    v_dot2c_f32_bf16 v49, v153, v153
    v_dot2c_f32_bf16 v50, s44, v155
    v_dot2c_f32_bf16 v51, v155, v155
    v_dot2c_f32_bf16 v52, s44, v157
    v_dot2c_f32_bf16 v53, v157, v157
    v_dot2c_f32_bf16 v54, s44, v159
    v_dot2c_f32_bf16 v55, v159, v159
    s_cmp_eq_u32 s74, 1
    s_cselect_b64 s[48:49], -1, 0
    v_cndmask_b32 v40, v152, v156, s[48:49]
    v_cndmask_b32 v41, v153, v157, s[48:49]
    v_cndmask_b32 v42, v154, v158, s[48:49]
    v_cndmask_b32 v43, v155, v159, s[48:49]
    s_mov_b32 s61, 0x20000
    s_waitcnt vmcnt(12)
L_ffn_h1:
    v_max3_u32 v44, v160, v161, v162
    v_max3_u32 v45, v163, v164, v165
    v_max3_u32 v44, v44, v166, v167
    v_max_u32 v44, v44, v45
    v_cmp_eq_u32 vcc, -1, v44
    s_nop 1
    s_cmp_lg_u64 vcc, 0
    s_cbranch_scc1 L_ffn_h1_r
L_ffn_h1_x:
    s_add_u32 s57, s34, 1
    s_and_b32 s57, s57, 7
    s_lshl_b32 s57, s57, 12
    v_add_u32 v1, s57, v20
    ds_write_b64 v1, v[160:161] offset:0
    ds_write_b64 v1, v[162:163] offset:1024
    ds_write_b64 v1, v[164:165] offset:36864
    ds_write_b64 v1, v[166:167] offset:37888
    s_add_u32 m0, s65, 84992
    s_add_u32 s42, s64, 0
    buffer_load_dwordx4 v32, s[24:27], s42 offen lds
    v_dot2c_f32_bf16 v48, s44, v160
    v_dot2c_f32_bf16 v49, v160, v160
    v_dot2c_f32_bf16 v50, s44, v162
    v_dot2c_f32_bf16 v51, v162, v162
    v_dot2c_f32_bf16 v52, s44, v164
    v_dot2c_f32_bf16 v53, v164, v164
    v_dot2c_f32_bf16 v54, s44, v166
    v_dot2c_f32_bf16 v55, v166, v166
    v_dot2c_f32_bf16 v48, s44, v161
    v_dot2c_f32_bf16 v49, v161, v161
    v_dot2c_f32_bf16 v50, s44, v163
    v_dot2c_f32_bf16 v51, v163, v163
    v_dot2c_f32_bf16 v52, s44, v165
    v_dot2c_f32_bf16 v53, v165, v165
    v_dot2c_f32_bf16 v54, s44, v167
    v_dot2c_f32_bf16 v55, v167, v167
    s_mov_b32 s61, 0x20000
    s_waitcnt vmcnt(11)
L_ffn_h2:
    v_max3_u32 v44, v168, v169, v170
    v_max3_u32 v45, v171, v172, v173
    v_max3_u32 v44, v44, v174, v175
    v_max_u32 v44, v44, v45
    v_cmp_eq_u32 vcc, -1, v44
    s_nop 1
    s_cmp_lg_u64 vcc, 0
    s_cbranch_scc1 L_ffn_h2_r
L_ffn_h2_x:
    s_add_u32 s57, s34, 2
    s_and_b32 s57, s57, 7
    s_lshl_b32 s57, s57, 12
    v_add_u32 v1, s57, v20
    ds_write_b64 v1, v[168:169] offset:0
    ds_write_b64 v1, v[170:171] offset:1024
    ds_write_b64 v1, v[172:173] offset:36864
    ds_write_b64 v1, v[174:175] offset:37888
    s_add_u32 m0, s65, 89088
    s_add_u32 s42, s64, 1024
    buffer_load_dwordx4 v32, s[24:27], s42 offen lds
    v_dot2c_f32_bf16 v48, s44, v168
    v_dot2c_f32_bf16 v49, v168, v168
    v_dot2c_f32_bf16 v50, s44, v170
    v_dot2c_f32_bf16 v51, v170, v170
    v_dot2c_f32_bf16 v52, s44, v172
    v_dot2c_f32_bf16 v53, v172, v172
    v_dot2c_f32_bf16 v54, s44, v174
    v_dot2c_f32_bf16 v55, v174, v174
    v_dot2c_f32_bf16 v48, s44, v169
    v_dot2c_f32_bf16 v49, v169, v169
    v_dot2c_f32_bf16 v50, s44, v171
    v_dot2c_f32_bf16 v51, v171, v171
    v_dot2c_f32_bf16 v52, s44, v173
    v_dot2c_f32_bf16 v53, v173, v173
    v_dot2c_f32_bf16 v54, s44, v175
    v_dot2c_f32_bf16 v55, v175, v175
    s_mov_b32 s61, 0x20000
    s_waitcnt vmcnt(10)
L_ffn_h3:
    v_max3_u32 v44, v176, v177, v178
    v_max3_u32 v45, v179, v180, v181
    v_max3_u32 v44, v44, v182, v183
    v_max_u32 v44, v44, v45
    v_cmp_eq_u32 vcc, -1, v44
    s_nop 1
    s_cmp_lg_u64 vcc, 0
    s_cbranch_scc1 L_ffn_h3_r
L_ffn_h3_x:
    s_add_u32 s57, s34, 3
    s_and_b32 s57, s57, 7
    s_lshl_b32 s57, s57, 12
    v_add_u32 v1, s57, v20
    ds_write_b64 v1, v[176:177] offset:0
    ds_write_b64 v1, v[178:179] offset:1024
    ds_write_b64 v1, v[180:181] offset:36864
    ds_write_b64 v1, v[182:183] offset:37888
    s_add_u32 m0, s65, 93184
    s_add_u32 s42, s64, 2048
    buffer_load_dwordx4 v32, s[24:27], s42 offen lds
    v_dot2c_f32_bf16 v48, s44, v176
    v_dot2c_f32_bf16 v49, v176, v176
    v_dot2c_f32_bf16 v50, s44, v178
    v_dot2c_f32_bf16 v51, v178, v178
    v_dot2c_f32_bf16 v52, s44, v180
    v_dot2c_f32_bf16 v53, v180, v180
    v_dot2c_f32_bf16 v54, s44, v182
    v_dot2c_f32_bf16 v55, v182, v182
    v_dot2c_f32_bf16 v48, s44, v177
    v_dot2c_f32_bf16 v49, v177, v177
    v_dot2c_f32_bf16 v50, s44, v179
    v_dot2c_f32_bf16 v51, v179, v179
    v_dot2c_f32_bf16 v52, s44, v181
    v_dot2c_f32_bf16 v53, v181, v181
    v_dot2c_f32_bf16 v54, s44, v183
    v_dot2c_f32_bf16 v55, v183, v183
    s_mov_b32 s61, 0x20000
    s_waitcnt vmcnt(9)
L_ffn_h4:
    v_max3_u32 v44, v184, v185, v186
    v_max3_u32 v45, v187, v188, v189
    v_max3_u32 v44, v44, v190, v191
    v_max_u32 v44, v44, v45
    v_cmp_eq_u32 vcc, -1, v44
    s_nop 1
    s_cmp_lg_u64 vcc, 0
    s_cbranch_scc1 L_ffn_h4_r
L_ffn_h4_x:
    s_add_u32 s57, s34, 4
    s_and_b32 s57, s57, 7
    s_lshl_b32 s57, s57, 12
    v_add_u32 v1, s57, v20
    ds_write_b64 v1, v[184:185] offset:0
    ds_write_b64 v1, v[186:187] offset:1024
    ds_write_b64 v1, v[188:189] offset:36864
    ds_write_b64 v1, v[190:191] offset:37888
    s_add_u32 m0, s65, 97280
    s_add_u32 s42, s64, 3072
    buffer_load_dwordx4 v32, s[24:27], s42 offen lds
    v_dot2c_f32_bf16 v48, s44, v184
    v_dot2c_f32_bf16 v49, v184, v184
    v_dot2c_f32_bf16 v50, s44, v186
    v_dot2c_f32_bf16 v51, v186, v186
    v_dot2c_f32_bf16 v52, s44, v188
    v_dot2c_f32_bf16 v53, v188, v188
    v_dot2c_f32_bf16 v54, s44, v190
    v_dot2c_f32_bf16 v55, v190, v190
    v_dot2c_f32_bf16 v48, s44, v185
    v_dot2c_f32_bf16 v49, v185, v185
    v_dot2c_f32_bf16 v50, s44, v187
    v_dot2c_f32_bf16 v51, v187, v187
    v_dot2c_f32_bf16 v52, s44, v189
    v_dot2c_f32_bf16 v53, v189, v189
    v_dot2c_f32_bf16 v54, s44, v191
    v_dot2c_f32_bf16 v55, v191, v191
    s_mov_b32 s61, 0x20000
    s_waitcnt vmcnt(8)
L_ffn_h5:
    v_max3_u32 v44, v192, v193, v194
    v_max3_u32 v45, v195, v196, v197
    v_max3_u32 v44, v44, v198, v199
    v_max_u32 v44, v44, v45
    v_cmp_eq_u32 vcc, -1, v44
    s_nop 1
    s_cmp_lg_u64 vcc, 0
    s_cbranch_scc1 L_ffn_h5_r
L_ffn_h5_x:
    s_add_u32 s57, s34, 5
    s_and_b32 s57, s57, 7
    s_lshl_b32 s57, s57, 12
    v_add_u32 v1, s57, v20
    ds_write_b64 v1, v[192:193] offset:0
    ds_write_b64 v1, v[194:195] offset:1024
    ds_write_b64 v1, v[196:197] offset:36864
    ds_write_b64 v1, v[198:199] offset:37888
    s_add_u32 m0, s65, 101376
    s_add_u32 s42, s64, 4096
    buffer_load_dwordx4 v32, s[24:27], s42 offen lds
    v_dot2c_f32_bf16 v48, s44, v192
    v_dot2c_f32_bf16 v49, v192, v192
    v_dot2c_f32_bf16 v50, s44, v194
    v_dot2c_f32_bf16 v51, v194, v194
    v_dot2c_f32_bf16 v52, s44, v196
    v_dot2c_f32_bf16 v53, v196, v196
    v_dot2c_f32_bf16 v54, s44, v198
    v_dot2c_f32_bf16 v55, v198, v198
    v_dot2c_f32_bf16 v48, s44, v193
    v_dot2c_f32_bf16 v49, v193, v193
    v_dot2c_f32_bf16 v50, s44, v195
    v_dot2c_f32_bf16 v51, v195, v195
    v_dot2c_f32_bf16 v52, s44, v197
    v_dot2c_f32_bf16 v53, v197, v197
    v_dot2c_f32_bf16 v54, s44, v199
    v_dot2c_f32_bf16 v55, v199, v199
    s_mov_b32 s61, 0x20000
    s_waitcnt vmcnt(7)
L_ffn_h6:
    v_max3_u32 v44, v200, v201, v202
    v_max3_u32 v45, v203, v204, v205
    v_max3_u32 v44, v44, v206, v207
    v_max_u32 v44, v44, v45
    v_cmp_eq_u32 vcc, -1, v44
    s_nop 1
    s_cmp_lg_u64 vcc, 0
    s_cbranch_scc1 L_ffn_h6_r
L_ffn_h6_x:
    s_add_u32 s57, s34, 6
    s_and_b32 s57, s57, 7
    s_lshl_b32 s57, s57, 12
    v_add_u32 v1, s57, v20
    ds_write_b64 v1, v[200:201] offset:0
    ds_write_b64 v1, v[202:203] offset:1024
    ds_write_b64 v1, v[204:205] offset:36864
    ds_write_b64 v1, v[206:207] offset:37888
    s_add_u32 m0, s65, 105472
    s_add_u32 s42, s64, 5120
    buffer_load_dwordx4 v32, s[24:27], s42 offen lds
    v_dot2c_f32_bf16 v48, s44, v200
    v_dot2c_f32_bf16 v49, v200, v200
    v_dot2c_f32_bf16 v50, s44, v202
    v_dot2c_f32_bf16 v51, v202, v202
    v_dot2c_f32_bf16 v52, s44, v204
    v_dot2c_f32_bf16 v53, v204, v204
    v_dot2c_f32_bf16 v54, s44, v206
    v_dot2c_f32_bf16 v55, v206, v206
    v_dot2c_f32_bf16 v48, s44, v201
    v_dot2c_f32_bf16 v49, v201, v201
    v_dot2c_f32_bf16 v50, s44, v203
    v_dot2c_f32_bf16 v51, v203, v203
    v_dot2c_f32_bf16 v52, s44, v205
    v_dot2c_f32_bf16 v53, v205, v205
    v_dot2c_f32_bf16 v54, s44, v207
    v_dot2c_f32_bf16 v55, v207, v207
    s_mov_b32 s61, 0x20000
    s_waitcnt vmcnt(6)
L_ffn_h7:
    v_max3_u32 v44, v208, v209, v210
    v_max3_u32 v45, v211, v212, v213
    v_max3_u32 v44, v44, v214, v215
    v_max_u32 v44, v44, v45
    v_cmp_eq_u32 vcc, -1, v44
    s_nop 1
    s_cmp_lg_u64 vcc, 0
    s_cbranch_scc1 L_ffn_h7_r
L_ffn_h7_x:
    s_add_u32 s57, s34, 7
    s_and_b32 s57, s57, 7
    s_lshl_b32 s57, s57, 12
    v_add_u32 v1, s57, v20
    ds_write_b64 v1, v[208:209] offset:0
    ds_write_b64 v1, v[210:211] offset:1024
    ds_write_b64 v1, v[212:213] offset:36864
    ds_write_b64 v1, v[214:215] offset:37888
    s_add_u32 m0, s65, 109568
    s_add_u32 s42, s64, 6144
    buffer_load_dwordx4 v32, s[24:27], s42 offen lds
    s_waitcnt lgkmcnt(0)
    s_barrier
    ds_read_b128 a[0:3], v32 offset:0
    ds_read_b128 a[4:7], v32 offset:1024
    ds_read_b128 a[8:11], v33 offset:0
    ds_read_b128 a[12:15], v33 offset:1024
    ds_read_b128 a[16:19], v32 offset:2048
    ds_read_b128 a[20:23], v32 offset:3072
    ds_read_b128 a[24:27], v33 offset:2048
    ds_read_b128 a[28:31], v33 offset:3072
    ds_read_b128 a[32:35], v32 offset:4096
    ds_read_b128 a[36:39], v32 offset:5120
    ds_read_b128 a[40:43], v33 offset:4096
    ds_read_b128 a[44:47], v33 offset:5120
    v_dot2c_f32_bf16 v48, s44, v208
    v_dot2c_f32_bf16 v49, v208, v208
    v_dot2c_f32_bf16 v50, s44, v210
    v_dot2c_f32_bf16 v51, v210, v210
    v_dot2c_f32_bf16 v52, s44, v212
    v_dot2c_f32_bf16 v53, v212, v212
    v_dot2c_f32_bf16 v54, s44, v214
    v_dot2c_f32_bf16 v55, v214, v214
    v_dot2c_f32_bf16 v48, s44, v209
    v_dot2c_f32_bf16 v49, v209, v209
    v_dot2c_f32_bf16 v50, s44, v211
    v_dot2c_f32_bf16 v51, v211, v211
    v_dot2c_f32_bf16 v52, s44, v213
    v_dot2c_f32_bf16 v53, v213, v213
    v_dot2c_f32_bf16 v54, s44, v215
    v_dot2c_f32_bf16 v55, v215, v215
    s_waitcnt vmcnt(16)
    s_waitcnt lgkmcnt(8)
    v_mfma_f32_16x16x32_bf16 v[80:83], a[184:187], a[0:3], 0
    buffer_load_dwordx4 a[252:255], v32, s[24:27], s43 offen offset:1024
    s_mov_b32 s43, s55
    v_mfma_f32_16x16x32_bf16 v[84:87], a[184:187], a[4:7], 0
    ds_read_b128 a[48:51], v32 offset:6144
    ds_read_b128 a[52:55], v32 offset:7168
    v_mfma_f32_16x16x32_bf16 v[88:91], a[184:187], a[8:11], 0
    ds_read_b128 a[56:59], v33 offset:6144
    ds_read_b128 a[60:63], v33 offset:7168
    v_mfma_f32_16x16x32_bf16 v[92:95], a[184:187], a[12:15], 0
    s_add_u32 m0, s65, 113664
    s_add_u32 s42, s64, 7168
    buffer_load_dwordx4 v32, s[24:27], s42 offen lds
    s_waitcnt vmcnt(16)
    s_waitcnt lgkmcnt(8)
    v_mfma_f32_16x16x32_bf16 v[80:83], a[188:191], a[16:19], v[80:83]
    buffer_load_dwordx4 a[184:187], v32, s[24:27], s43 offen offset:0
    ds_read_b128 a[64:67], v32 offset:8192
    v_mfma_f32_16x16x32_bf16 v[84:87], a[188:191], a[20:23], v[84:87]
    ds_read_b128 a[68:71], v32 offset:9216
    ds_read_b128 a[72:75], v33 offset:8192
    ds_read_b128 a[76:79], v33 offset:9216
    v_mov_b32 v56, v48
    v_mfma_f32_16x16x32_bf16 v[88:91], a[188:191], a[24:27], v[88:91]
    v_mov_b32 v57, v49
    v_mov_b32 v58, v50
    v_mov_b32 v59, v51
    v_mov_b32 v60, v52
    v_mfma_f32_16x16x32_bf16 v[92:95], a[188:191], a[28:31], v[92:95]
    v_mov_b32 v61, v53
    s_add_u32 m0, s65, 117760
    s_add_u32 s42, s64, 8192
    buffer_load_dwordx4 v32, s[24:27], s42 offen lds
    s_waitcnt vmcnt(16)
    s_waitcnt lgkmcnt(8)
    v_mfma_f32_16x16x32_bf16 v[80:83], a[192:195], a[32:35], v[80:83]
    buffer_load_dwordx4 a[188:191], v32, s[24:27], s43 offen offset:1024
    ds_read_b128 a[80:83], v32 offset:10240
    v_mfma_f32_16x16x32_bf16 v[84:87], a[192:195], a[36:39], v[84:87]
    ds_read_b128 a[84:87], v32 offset:11264
    ds_read_b128 a[88:91], v33 offset:10240
    ds_read_b128 a[92:95], v33 offset:11264
    s_add_u32 s55, s55, 18432
    v_mfma_f32_16x16x32_bf16 v[88:91], a[192:195], a[40:43], v[88:91]
    v_mov_b32 v62, v54
    v_mov_b32 v63, v55
    v_permlane32_swap_b32 v48, v56
    v_permlane32_swap_b32 v49, v57
    v_mfma_f32_16x16x32_bf16 v[92:95], a[192:195], a[44:47], v[92:95]
    v_permlane32_swap_b32 v50, v58
    v_permlane32_swap_b32 v51, v59
    s_waitcnt vmcnt(16)
    s_waitcnt lgkmcnt(8)
    v_mfma_f32_16x16x32_bf16 v[80:83], a[196:199], a[48:51], v[80:83]
    buffer_load_dwordx4 a[192:195], v32, s[24:27], s43 offen offset:2048
    ds_read_b128 a[96:99], v32 offset:12288
    v_mfma_f32_16x16x32_bf16 v[84:87], a[196:199], a[52:55], v[84:87]
    ds_read_b128 a[100:103], v32 offset:13312
    ds_read_b128 a[104:107], v33 offset:12288
    ds_read_b128 a[108:111], v33 offset:13312
    v_permlane32_swap_b32 v52, v60
    v_mfma_f32_16x16x32_bf16 v[88:91], a[196:199], a[56:59], v[88:91]
    v_permlane32_swap_b32 v53, v61
    v_permlane32_swap_b32 v54, v62
    v_permlane32_swap_b32 v55, v63
    v_add_f32 v48, v48, v56
    v_mfma_f32_16x16x32_bf16 v[92:95], a[196:199], a[60:63], v[92:95]
    v_add_f32 v49, v49, v57
    s_add_u32 m0, s65, 121856
    s_add_u32 s42, s64, 9216
    buffer_load_dwordx4 v32, s[24:27], s42 offen lds
    s_waitcnt vmcnt(16)
    s_waitcnt lgkmcnt(8)
    v_mfma_f32_16x16x32_bf16 v[80:83], a[200:203], a[64:67], v[80:83]
    buffer_load_dwordx4 a[196:199], v32, s[24:27], s43 offen offset:3072
    s_add_u32 s43, s43, 4096
    ds_read_b128 a[112:115], v32 offset:14336
    v_mfma_f32_16x16x32_bf16 v[84:87], a[200:203], a[68:71], v[84:87]
    ds_read_b128 a[116:119], v32 offset:15360
    ds_read_b128 a[120:123], v33 offset:14336
    ds_read_b128 a[124:127], v33 offset:15360
    v_add_f32 v50, v50, v58
    v_mfma_f32_16x16x32_bf16 v[88:91], a[200:203], a[72:75], v[88:91]
    v_add_f32 v51, v51, v59
    v_add_f32 v52, v52, v60
    v_add_f32 v53, v53, v61
    v_add_f32 v54, v54, v62
    v_mfma_f32_16x16x32_bf16 v[92:95], a[200:203], a[76:79], v[92:95]
    v_add_f32 v55, v55, v63
    s_add_u32 m0, s65, 125952
    s_add_u32 s42, s64, 10240
    buffer_load_dwordx4 v32, s[24:27], s42 offen lds
    s_waitcnt vmcnt(16)
    s_waitcnt lgkmcnt(8)
    v_mfma_f32_16x16x32_bf16 v[80:83], a[204:207], a[80:83], v[80:83]
    buffer_load_dwordx4 a[200:203], v32, s[24:27], s43 offen offset:0
    ds_read_b128 a[128:131], v32 offset:16384
    v_mfma_f32_16x16x32_bf16 v[84:87], a[204:207], a[84:87], v[84:87]
    ds_read_b128 a[132:135], v32 offset:17408
    ds_read_b128 a[136:139], v33 offset:16384
    ds_read_b128 a[140:143], v33 offset:17408
    v_mov_b32 v56, v48
    v_mfma_f32_16x16x32_bf16 v[88:91], a[204:207], a[88:91], v[88:91]
    v_mov_b32 v57, v49
    v_mov_b32 v58, v50
    v_mov_b32 v59, v51
    v_mov_b32 v60, v52
    v_mfma_f32_16x16x32_bf16 v[92:95], a[204:207], a[92:95], v[92:95]
    v_mov_b32 v61, v53
    s_waitcnt vmcnt(16)
    s_waitcnt lgkmcnt(8)
    v_mfma_f32_16x16x32_bf16 v[80:83], a[208:211], a[96:99], v[80:83]
    buffer_load_dwordx4 a[204:207], v32, s[24:27], s43 offen offset:1024
    ds_read_b128 a[144:147], v32 offset:18432
    v_mfma_f32_16x16x32_bf16 v[84:87], a[208:211], a[100:103], v[84:87]
    ds_read_b128 a[148:151], v32 offset:19456
    ds_read_b128 a[152:155], v33 offset:18432
    ds_read_b128 a[156:159], v33 offset:19456
    v_mov_b32 v62, v54
    v_mfma_f32_16x16x32_bf16 v[88:91], a[208:211], a[104:107], v[88:91]
    v_mov_b32 v63, v55
    v_permlane16_swap_b32 v48, v56
    v_permlane16_swap_b32 v49, v57
    v_permlane16_swap_b32 v50, v58
    v_mfma_f32_16x16x32_bf16 v[92:95], a[208:211], a[108:111], v[92:95]
    v_permlane16_swap_b32 v51, v59
    s_add_u32 m0, s65, 130048
    s_add_u32 s42, s64, 11264
    buffer_load_dwordx4 v32, s[24:27], s42 offen lds
    s_waitcnt vmcnt(16)
    s_waitcnt lgkmcnt(8)
    v_mfma_f32_16x16x32_bf16 v[80:83], a[212:215], a[112:115], v[80:83]
    buffer_load_dwordx4 a[208:211], v32, s[24:27], s43 offen offset:2048
    ds_read_b128 a[160:163], v32 offset:20480
    v_mfma_f32_16x16x32_bf16 v[84:87], a[212:215], a[116:119], v[84:87]
    ds_read_b128 a[164:167], v32 offset:21504
    ds_read_b128 a[168:171], v33 offset:20480
    ds_read_b128 a[172:175], v33 offset:21504
    v_permlane16_swap_b32 v52, v60
    v_mfma_f32_16x16x32_bf16 v[88:91], a[212:215], a[120:123], v[88:91]
    v_permlane16_swap_b32 v53, v61
    v_permlane16_swap_b32 v54, v62
    v_permlane16_swap_b32 v55, v63
    v_add_f32 v48, v48, v56
    v_mfma_f32_16x16x32_bf16 v[92:95], a[212:215], a[124:127], v[92:95]
    v_add_f32 v49, v49, v57
    s_waitcnt vmcnt(16)
    s_waitcnt lgkmcnt(8)
    v_mfma_f32_16x16x32_bf16 v[80:83], a[216:219], a[128:131], v[80:83]
    buffer_load_dwordx4 a[212:215], v32, s[24:27], s43 offen offset:3072
    s_add_u32 s43, s43, 4096
    ds_read_b128 a[176:179], v32 offset:22528
    v_mfma_f32_16x16x32_bf16 v[84:87], a[216:219], a[132:135], v[84:87]
    ds_read_b128 a[180:183], v32 offset:23552
    ds_read_b128 v[152:155], v33 offset:22528
    ds_read_b128 v[156:159], v33 offset:23552
    v_add_f32 v50, v50, v58
    v_mfma_f32_16x16x32_bf16 v[88:91], a[216:219], a[136:139], v[88:91]
    v_add_f32 v51, v51, v59
    v_add_f32 v52, v52, v60
    v_add_f32 v53, v53, v61
    v_add_f32 v54, v54, v62
    v_mfma_f32_16x16x32_bf16 v[92:95], a[216:219], a[140:143], v[92:95]
    v_add_f32 v55, v55, v63
    s_add_u32 m0, s65, 134144
    s_add_u32 s42, s64, 12288
    buffer_load_dwordx4 v32, s[24:27], s42 offen lds
    s_waitcnt vmcnt(16)
    s_waitcnt lgkmcnt(8)
    v_mfma_f32_16x16x32_bf16 v[80:83], a[220:223], a[144:147], v[80:83]
    buffer_load_dwordx4 a[216:219], v32, s[24:27], s43 offen offset:0
    ds_read_b128 v[160:163], v32 offset:24576
    v_mfma_f32_16x16x32_bf16 v[84:87], a[220:223], a[148:151], v[84:87]
    ds_read_b128 v[164:167], v32 offset:25600
    ds_read_b128 v[168:171], v33 offset:24576
    ds_read_b128 v[172:175], v33 offset:25600
    v_mfma_f32_16x16x32_bf16 v[88:91], a[220:223], a[152:155], v[88:91]
    ds_write_b128 v22, v[48:51]
    ds_write_b128 v22, v[52:55] offset:16
    s_add_u32 m0, s65, 138240
    s_add_u32 s42, s64, 13312
    buffer_load_dwordx4 v32, s[24:27], s42 offen lds
    v_mfma_f32_16x16x32_bf16 v[92:95], a[220:223], a[156:159], v[92:95]
    s_waitcnt vmcnt(16)
    s_waitcnt lgkmcnt(10)
    v_mfma_f32_16x16x32_bf16 v[80:83], a[224:227], a[160:163], v[80:83]
    buffer_load_dwordx4 a[220:223], v32, s[24:27], s43 offen offset:1024
    v_mfma_f32_16x16x32_bf16 v[84:87], a[224:227], a[164:167], v[84:87]
    ds_read_b128 v[176:179], v32 offset:26624
    ds_read_b128 v[180:183], v32 offset:27648
    v_mfma_f32_16x16x32_bf16 v[88:91], a[224:227], a[168:171], v[88:91]
    ds_read_b128 v[184:187], v33 offset:26624
    ds_read_b128 v[188:191], v33 offset:27648
    v_mfma_f32_16x16x32_bf16 v[92:95], a[224:227], a[172:175], v[92:95]
    s_waitcnt vmcnt(16)
    s_waitcnt lgkmcnt(10)
    v_mfma_f32_16x16x32_bf16 v[80:83], a[228:231], a[176:179], v[80:83]
    buffer_load_dwordx4 a[224:227], v32, s[24:27], s43 offen offset:2048
    ds_read_b128 v[192:195], v32 offset:28672
    v_mfma_f32_16x16x32_bf16 v[84:87], a[228:231], a[180:183], v[84:87]
    ds_read_b128 v[196:199], v32 offset:29696
    ds_read_b128 v[200:203], v33 offset:28672
    v_mfma_f32_16x16x32_bf16 v[88:91], a[228:231], v[152:155], v[88:91]
    ds_read_b128 v[204:207], v33 offset:29696
    v_lshlrev_b32 v5, 5, v3
    v_lshl_add_u32 v5, v4, 3, v5
    v_add_u32 v5, 78848, v5
    s_lshl_b32 s57, s38, 10
    s_add_u32 s57, s57, 80896
    v_add_u32 v6, s57, v32
    v_lshl_add_u32 v7, v3, 4, s57
    s_waitcnt lgkmcnt(8)
    s_barrier
    ds_read_b64 v[48:49], v5 offset:0
    ds_read_b64 v[50:51], v5 offset:512
    ds_read_b64 v[52:53], v5 offset:1024
    ds_read_b64 v[54:55], v5 offset:1536
    ds_read_b64 v[38:39], v21
    v_mfma_f32_16x16x32_bf16 v[92:95], a[228:231], v[156:159], v[92:95]
    s_add_u32 m0, s65, 142336
    s_add_u32 s42, s64, 14336
    buffer_load_dwordx4 v32, s[24:27], s42 offen lds
    s_waitcnt vmcnt(16)
    v_mfma_f32_16x16x32_bf16 v[80:83], a[232:235], v[160:163], v[80:83]
    buffer_load_dwordx4 a[228:231], v32, s[24:27], s43 offen offset:3072
    s_add_u32 s43, s43, 4096
    v_mfma_f32_16x16x32_bf16 v[84:87], a[232:235], v[164:167], v[84:87]
    ds_read_b128 v[208:211], v32 offset:30720
    ds_read_b128 v[212:215], v32 offset:31744
    v_mfma_f32_16x16x32_bf16 v[88:91], a[232:235], v[168:171], v[88:91]
    ds_read_b128 v[216:219], v33 offset:30720
    ds_read_b128 v[220:223], v33 offset:31744
    v_mfma_f32_16x16x32_bf16 v[92:95], a[232:235], v[172:175], v[92:95]
    s_waitcnt vmcnt(16)
    s_waitcnt lgkmcnt(13)
    v_mfma_f32_16x16x32_bf16 v[80:83], a[236:239], v[176:179], v[80:83]
    buffer_load_dwordx4 a[232:235], v32, s[24:27], s43 offen offset:0
    ds_read_b128 v[224:227], v32 offset:32768
    v_mfma_f32_16x16x32_bf16 v[84:87], a[236:239], v[180:183], v[84:87]
    ds_read_b128 v[228:231], v32 offset:33792
    ds_read_b128 v[232:235], v33 offset:32768
    v_mfma_f32_16x16x32_bf16 v[88:91], a[236:239], v[184:187], v[88:91]
    ds_read_b128 v[236:239], v33 offset:33792
    s_waitcnt lgkmcnt(9)
    v_add_f32 v48, v48, v50
    v_add_f32 v49, v49, v51
    v_add_f32 v48, v48, v52
    v_add_f32 v49, v49, v53
    v_add_f32 v48, v48, v54
    v_add_f32 v49, v49, v55
    v_mul_f32 v48, 0xbae38e39, v48
    v_mul_f32 v49, 0x3ae38e39, v49
    v_fma_f32 v49, -v48, v48, v49
    v_max_f32 v49, 0, v49
    v_add_f32 v49, 0x3727c5ac, v49
    v_rcp_f32 v59, v49
    v_sqrt_f32 v49, v49
    v_and_b32 v50, s58, v48
    v_sub_f32 v48, v48, v50
    v_and_b32 v51, s58, v49
    v_sub_f32 v49, v49, v51
    v_cvt_pk_bf16_f32 v56, v50, v50
    v_cvt_pk_bf16_f32 v57, v48, v51
    v_cvt_pk_bf16_f32 v58, v14, v49
    ds_write_b128 v6, v[56:59]
    ds_read_b128 v[112:115], v7 offset:0
    ds_read_b128 v[116:119], v7 offset:256
    ds_read_b128 v[120:123], v7 offset:512
    ds_read_b128 v[124:127], v7 offset:768
    v_cmp_eq_u32 vcc, 0, v4
    v_cmp_eq_u32 s[48:49], 1, v4
    v_mfma_f32_16x16x32_bf16 v[92:95], a[236:239], v[188:191], v[92:95]
    s_add_u32 m0, s65, 146432
    s_add_u32 s42, s64, 15360
    buffer_load_dwordx4 v32, s[24:27], s42 offen lds
    s_waitcnt vmcnt(16)
    v_mfma_f32_16x16x32_bf16 v[80:83], a[240:243], v[192:195], v[80:83]
    buffer_load_dwordx4 a[236:239], v32, s[24:27], s43 offen offset:1024
    v_mfma_f32_16x16x32_bf16 v[84:87], a[240:243], v[196:199], v[84:87]
    ds_read_b128 v[240:243], v32 offset:34816
    ds_read_b128 v[244:247], v32 offset:35840
    v_mfma_f32_16x16x32_bf16 v[88:91], a[240:243], v[200:203], v[88:91]
    ds_read_b128 v[248:251], v33 offset:34816
    ds_read_b128 v[252:255], v33 offset:35840
    v_mfma_f32_16x16x32_bf16 v[92:95], a[240:243], v[204:207], v[92:95]
    s_add_u32 m0, s65, 150528
    s_add_u32 s42, s64, 16384
    buffer_load_dwordx4 v32, s[24:27], s42 offen lds
    s_waitcnt vmcnt(16)
    s_waitcnt lgkmcnt(13)
    v_mfma_f32_16x16x32_bf16 v[80:83], a[244:247], v[208:211], v[80:83]
    buffer_load_dwordx4 a[240:243], v32, s[24:27], s43 offen offset:2048
    v_mfma_f32_16x16x32_bf16 v[84:87], a[244:247], v[212:215], v[84:87]
    v_mfma_f32_16x16x32_bf16 v[88:91], a[244:247], v[216:219], v[88:91]
    v_mfma_f32_16x16x32_bf16 v[92:95], a[244:247], v[220:223], v[92:95]
    s_waitcnt vmcnt(16)
    s_waitcnt lgkmcnt(9)
    v_mfma_f32_16x16x32_bf16 v[80:83], a[248:251], v[224:227], v[80:83]
    buffer_load_dwordx4 a[244:247], v32, s[24:27], s43 offen offset:3072
    s_add_u32 s43, s43, 4096
    v_mfma_f32_16x16x32_bf16 v[84:87], a[248:251], v[228:231], v[84:87]
    s_waitcnt lgkmcnt(4)
    v_cndmask_b32 v72, v14, v112, vcc
    v_cndmask_b32 v73, v14, v113, vcc
    v_cndmask_b32 v73, v73, v114, s[48:49]
    v_mov_b32 v34, v115
    v_cndmask_b32 v74, v14, v116, vcc
    v_cndmask_b32 v75, v14, v117, vcc
    v_cndmask_b32 v75, v75, v118, s[48:49]
    v_mov_b32 v35, v119
    v_cndmask_b32 v76, v14, v120, vcc
    v_cndmask_b32 v77, v14, v121, vcc
    v_cndmask_b32 v77, v77, v122, s[48:49]
    v_mov_b32 v36, v123
    v_cndmask_b32 v78, v14, v124, vcc
    v_cndmask_b32 v79, v14, v125, vcc
    v_cndmask_b32 v79, v79, v126, s[48:49]
    v_mov_b32 v37, v127
    v_mfma_f32_16x16x32_bf16 v[88:91], a[248:251], v[232:235], v[88:91]
    s_add_u32 m0, s65, 154624
    s_add_u32 s42, s64, 17408
    buffer_load_dwordx4 v32, s[24:27], s42 offen lds
    v_mfma_f32_16x16x32_bf16 v[92:95], a[248:251], v[236:239], v[92:95]
    s_waitcnt vmcnt(16)
    s_waitcnt lgkmcnt(0)
    v_mfma_f32_16x16x32_bf16 v[80:83], a[252:255], v[240:243], v[80:83]
    buffer_load_dwordx4 a[248:251], v32, s[24:27], s43 offen offset:0
    v_mfma_f32_16x16x32_bf16 v[84:87], a[252:255], v[244:247], v[84:87]
    s_barrier
    v_mfma_f32_16x16x32_bf16 v[88:91], a[252:255], v[248:251], v[88:91]
    v_mfma_f32_16x16x32_bf16 v[92:95], a[252:255], v[252:255], v[92:95]
    v_mfma_f32_16x16x16_bf16 v[80:83], v[38:39], v[72:73], v[80:83]
    v_mfma_f32_16x16x16_bf16 v[84:87], v[38:39], v[74:75], v[84:87]
    v_mfma_f32_16x16x16_bf16 v[88:91], v[38:39], v[76:77], v[88:91]
    v_mfma_f32_16x16x16_bf16 v[92:95], v[38:39], v[78:79], v[92:95]
    s_mov_b32 s62, 0
L_ffn_p1:
    s_waitcnt vmcnt(16)
    v_mfma_f32_16x16x32_bf16 v[96:99], a[184:187], a[0:3], 0
    buffer_load_dwordx4 a[252:255], v32, s[24:27], s43 offen offset:1024
    s_mov_b32 s43, s55
    v_mfma_f32_16x16x32_bf16 v[100:103], a[184:187], a[4:7], 0
    v_add_u32 v21, 512, v21
    v_mfma_f32_16x16x32_bf16 v[104:107], a[184:187], a[8:11], 0
    ds_read_b64 v[38:39], v21
    v_mfma_f32_16x16x32_bf16 v[108:111], a[184:187], a[12:15], 0
    s_waitcnt vmcnt(16)
    v_mfma_f32_16x16x32_bf16 v[96:99], a[188:191], a[16:19], v[96:99]
    buffer_load_dwordx4 a[184:187], v32, s[24:27], s43 offen offset:0
    v_mfma_f32_16x16x32_bf16 v[100:103], a[188:191], a[20:23], v[100:103]
    v_mul_f32 v80, v80, abs(v80)
    v_mfma_f32_16x16x32_bf16 v[104:107], a[188:191], a[24:27], v[104:107]
    v_mul_f32 v81, v81, abs(v81)
    v_mfma_f32_16x16x32_bf16 v[108:111], a[188:191], a[28:31], v[108:111]
    v_cvt_pk_bf16_f32 v64, v80, v81
    s_waitcnt vmcnt(16)
    v_mfma_f32_16x16x32_bf16 v[96:99], a[192:195], a[32:35], v[96:99]
    buffer_load_dwordx4 a[188:191], v32, s[24:27], s43 offen offset:1024
    v_mfma_f32_16x16x32_bf16 v[100:103], a[192:195], a[36:39], v[100:103]
    s_add_u32 s55, s55, 18432
    v_pk_max_i16 v64, v64, 0
    v_mfma_f32_16x16x32_bf16 v[104:107], a[192:195], a[40:43], v[104:107]
    v_mul_f32 v82, v82, abs(v82)
    v_mul_f32 v83, v83, abs(v83)
    v_mfma_f32_16x16x32_bf16 v[108:111], a[192:195], a[44:47], v[108:111]
    s_waitcnt vmcnt(16)
    v_mfma_f32_16x16x32_bf16 v[96:99], a[196:199], a[48:51], v[96:99]
    buffer_load_dwordx4 a[192:195], v32, s[24:27], s43 offen offset:2048
    v_mfma_f32_16x16x32_bf16 v[100:103], a[196:199], a[52:55], v[100:103]
    v_cvt_pk_bf16_f32 v65, v82, v83
    v_mfma_f32_16x16x32_bf16 v[104:107], a[196:199], a[56:59], v[104:107]
    v_pk_max_i16 v65, v65, 0
    v_mfma_f32_16x16x32_bf16 v[108:111], a[196:199], a[60:63], v[108:111]
    ds_write_b64 v20, v[64:65] offset:0
    s_waitcnt lgkmcnt(1)
    v_mfma_f32_16x16x16_bf16 v[96:99], v[38:39], v[72:73], v[96:99]
    v_mfma_f32_16x16x16_bf16 v[100:103], v[38:39], v[74:75], v[100:103]
    v_mfma_f32_16x16x16_bf16 v[104:107], v[38:39], v[76:77], v[104:107]
    v_mfma_f32_16x16x16_bf16 v[108:111], v[38:39], v[78:79], v[108:111]
    s_waitcnt vmcnt(16)
    v_mfma_f32_16x16x32_bf16 v[96:99], a[200:203], a[64:67], v[96:99]
    buffer_load_dwordx4 a[196:199], v32, s[24:27], s43 offen offset:3072
    s_add_u32 s43, s43, 4096
    v_mfma_f32_16x16x32_bf16 v[100:103], a[200:203], a[68:71], v[100:103]
    v_mul_f32 v84, v84, abs(v84)
    v_mfma_f32_16x16x32_bf16 v[104:107], a[200:203], a[72:75], v[104:107]
    v_mul_f32 v85, v85, abs(v85)
    v_mfma_f32_16x16x32_bf16 v[108:111], a[200:203], a[76:79], v[108:111]
    v_cvt_pk_bf16_f32 v66, v84, v85
    s_waitcnt vmcnt(16)
    v_mfma_f32_16x16x32_bf16 v[96:99], a[204:207], a[80:83], v[96:99]
    buffer_load_dwordx4 a[200:203], v32, s[24:27], s43 offen offset:0
    v_mfma_f32_16x16x32_bf16 v[100:103], a[204:207], a[84:87], v[100:103]
    v_pk_max_i16 v66, v66, 0
    v_mfma_f32_16x16x32_bf16 v[104:107], a[204:207], a[88:91], v[104:107]
    v_mul_f32 v86, v86, abs(v86)
    v_mfma_f32_16x16x32_bf16 v[108:111], a[204:207], a[92:95], v[108:111]
    v_mul_f32 v87, v87, abs(v87)
    s_waitcnt vmcnt(16)
    v_mfma_f32_16x16x32_bf16 v[96:99], a[208:211], a[96:99], v[96:99]
    buffer_load_dwordx4 a[204:207], v32, s[24:27], s43 offen offset:1024
    v_mfma_f32_16x16x32_bf16 v[100:103], a[208:211], a[100:103], v[100:103]
    v_cvt_pk_bf16_f32 v67, v86, v87
    v_mfma_f32_16x16x32_bf16 v[104:107], a[208:211], a[104:107], v[104:107]
    v_pk_max_i16 v67, v67, 0
    v_mfma_f32_16x16x32_bf16 v[108:111], a[208:211], a[108:111], v[108:111]
    ds_write_b64 v20, v[66:67] offset:1024
    s_waitcnt vmcnt(16)
    v_mfma_f32_16x16x32_bf16 v[96:99], a[212:215], a[112:115], v[96:99]
    buffer_load_dwordx4 a[208:211], v32, s[24:27], s43 offen offset:2048
    v_mfma_f32_16x16x32_bf16 v[100:103], a[212:215], a[116:119], v[100:103]
    v_mul_f32 v88, v88, abs(v88)
    v_mfma_f32_16x16x32_bf16 v[104:107], a[212:215], a[120:123], v[104:107]
    v_mul_f32 v89, v89, abs(v89)
    v_mfma_f32_16x16x32_bf16 v[108:111], a[212:215], a[124:127], v[108:111]
    v_cvt_pk_bf16_f32 v68, v88, v89
    s_waitcnt vmcnt(16)
    v_mfma_f32_16x16x32_bf16 v[96:99], a[216:219], a[128:131], v[96:99]
    buffer_load_dwordx4 a[212:215], v32, s[24:27], s43 offen offset:3072
    s_add_u32 s43, s43, 4096
    v_mfma_f32_16x16x32_bf16 v[100:103], a[216:219], a[132:135], v[100:103]
    v_pk_max_i16 v68, v68, 0
    v_mfma_f32_16x16x32_bf16 v[104:107], a[216:219], a[136:139], v[104:107]
    v_mul_f32 v90, v90, abs(v90)
    v_mfma_f32_16x16x32_bf16 v[108:111], a[216:219], a[140:143], v[108:111]
    v_mul_f32 v91, v91, abs(v91)
    s_waitcnt vmcnt(16)
    v_mfma_f32_16x16x32_bf16 v[96:99], a[220:223], a[144:147], v[96:99]
    buffer_load_dwordx4 a[216:219], v32, s[24:27], s43 offen offset:0
    v_mfma_f32_16x16x32_bf16 v[100:103], a[220:223], a[148:151], v[100:103]
    v_cvt_pk_bf16_f32 v69, v90, v91
    v_mfma_f32_16x16x32_bf16 v[104:107], a[220:223], a[152:155], v[104:107]
    v_pk_max_i16 v69, v69, 0
    v_mfma_f32_16x16x32_bf16 v[108:111], a[220:223], a[156:159], v[108:111]
    ds_write_b64 v20, v[68:69] offset:36864
    s_waitcnt vmcnt(16)
    v_mfma_f32_16x16x32_bf16 v[96:99], a[224:227], a[160:163], v[96:99]
    buffer_load_dwordx4 a[220:223], v32, s[24:27], s43 offen offset:1024
    v_mfma_f32_16x16x32_bf16 v[100:103], a[224:227], a[164:167], v[100:103]
    v_mul_f32 v92, v92, abs(v92)
    v_mfma_f32_16x16x32_bf16 v[104:107], a[224:227], a[168:171], v[104:107]
    v_mul_f32 v93, v93, abs(v93)
    v_mfma_f32_16x16x32_bf16 v[108:111], a[224:227], a[172:175], v[108:111]
    v_cvt_pk_bf16_f32 v70, v92, v93
    s_waitcnt vmcnt(16)
    v_mfma_f32_16x16x32_bf16 v[96:99], a[228:231], a[176:179], v[96:99]
    buffer_load_dwordx4 a[224:227], v32, s[24:27], s43 offen offset:2048
    v_mfma_f32_16x16x32_bf16 v[100:103], a[228:231], a[180:183], v[100:103]
    v_pk_max_i16 v70, v70, 0
    v_mfma_f32_16x16x32_bf16 v[104:107], a[228:231], v[152:155], v[104:107]
    v_mul_f32 v94, v94, abs(v94)
    v_mfma_f32_16x16x32_bf16 v[108:111], a[228:231], v[156:159], v[108:111]
    v_mul_f32 v95, v95, abs(v95)
    s_waitcnt vmcnt(16)
    v_mfma_f32_16x16x32_bf16 v[96:99], a[232:235], v[160:163], v[96:99]
    buffer_load_dwordx4 a[228:231], v32, s[24:27], s43 offen offset:3072
    s_add_u32 s43, s43, 4096
    v_mfma_f32_16x16x32_bf16 v[100:103], a[232:235], v[164:167], v[100:103]
    v_cvt_pk_bf16_f32 v71, v94, v95
    v_mfma_f32_16x16x32_bf16 v[104:107], a[232:235], v[168:171], v[104:107]
    v_pk_max_i16 v71, v71, 0
    v_mfma_f32_16x16x32_bf16 v[108:111], a[232:235], v[172:175], v[108:111]
    ds_write_b64 v20, v[70:71] offset:37888
    s_waitcnt vmcnt(16)
    v_mfma_f32_16x16x32_bf16 v[96:99], a[236:239], v[176:179], v[96:99]
    buffer_load_dwordx4 a[232:235], v32, s[24:27], s43 offen offset:0
    v_mfma_f32_16x16x32_bf16 v[100:103], a[236:239], v[180:183], v[100:103]
    v_add_u32 v20, 4096, v20
    v_mfma_f32_16x16x32_bf16 v[104:107], a[236:239], v[184:187], v[104:107]
    v_mfma_f32_16x16x32_bf16 v[108:111], a[236:239], v[188:191], v[108:111]
    s_waitcnt vmcnt(16)
    v_mfma_f32_16x16x32_bf16 v[96:99], a[240:243], v[192:195], v[96:99]
    buffer_load_dwordx4 a[236:239], v32, s[24:27], s43 offen offset:1024
    v_mfma_f32_16x16x32_bf16 v[100:103], a[240:243], v[196:199], v[100:103]
    v_mfma_f32_16x16x32_bf16 v[104:107], a[240:243], v[200:203], v[104:107]
    v_mfma_f32_16x16x32_bf16 v[108:111], a[240:243], v[204:207], v[108:111]
    s_waitcnt vmcnt(16)
    v_mfma_f32_16x16x32_bf16 v[96:99], a[244:247], v[208:211], v[96:99]
    buffer_load_dwordx4 a[240:243], v32, s[24:27], s43 offen offset:2048
    v_mfma_f32_16x16x32_bf16 v[100:103], a[244:247], v[212:215], v[100:103]
    v_mfma_f32_16x16x32_bf16 v[104:107], a[244:247], v[216:219], v[104:107]
    v_mfma_f32_16x16x32_bf16 v[108:111], a[244:247], v[220:223], v[108:111]
    s_waitcnt vmcnt(16)
    v_mfma_f32_16x16x32_bf16 v[96:99], a[248:251], v[224:227], v[96:99]
    buffer_load_dwordx4 a[244:247], v32, s[24:27], s43 offen offset:3072
    s_add_u32 s43, s43, 4096
    v_mfma_f32_16x16x32_bf16 v[100:103], a[248:251], v[228:231], v[100:103]
    v_mfma_f32_16x16x32_bf16 v[104:107], a[248:251], v[232:235], v[104:107]
    v_mfma_f32_16x16x32_bf16 v[108:111], a[248:251], v[236:239], v[108:111]
    s_waitcnt vmcnt(16)
    v_mfma_f32_16x16x32_bf16 v[96:99], a[252:255], v[240:243], v[96:99]
    buffer_load_dwordx4 a[248:251], v32, s[24:27], s43 offen offset:0
    v_mfma_f32_16x16x32_bf16 v[100:103], a[252:255], v[244:247], v[100:103]
    v_mfma_f32_16x16x32_bf16 v[104:107], a[252:255], v[248:251], v[104:107]
    v_mfma_f32_16x16x32_bf16 v[108:111], a[252:255], v[252:255], v[108:111]
    s_waitcnt vmcnt(16)
    v_mfma_f32_16x16x32_bf16 v[80:83], a[184:187], a[0:3], 0
    buffer_load_dwordx4 a[252:255], v32, s[24:27], s43 offen offset:1024
    s_mov_b32 s43, s55
    v_mfma_f32_16x16x32_bf16 v[84:87], a[184:187], a[4:7], 0
    v_add_u32 v21, 512, v21
    v_mfma_f32_16x16x32_bf16 v[88:91], a[184:187], a[8:11], 0
    ds_read_b64 v[38:39], v21
    v_mfma_f32_16x16x32_bf16 v[92:95], a[184:187], a[12:15], 0
    s_waitcnt vmcnt(16)
    v_mfma_f32_16x16x32_bf16 v[80:83], a[188:191], a[16:19], v[80:83]
    buffer_load_dwordx4 a[184:187], v32, s[24:27], s43 offen offset:0
    v_mfma_f32_16x16x32_bf16 v[84:87], a[188:191], a[20:23], v[84:87]
    v_mul_f32 v96, v96, abs(v96)
    v_mfma_f32_16x16x32_bf16 v[88:91], a[188:191], a[24:27], v[88:91]
    v_mul_f32 v97, v97, abs(v97)
    v_mfma_f32_16x16x32_bf16 v[92:95], a[188:191], a[28:31], v[92:95]
    v_cvt_pk_bf16_f32 v64, v96, v97
    s_waitcnt vmcnt(16)
    v_mfma_f32_16x16x32_bf16 v[80:83], a[192:195], a[32:35], v[80:83]
    buffer_load_dwordx4 a[188:191], v32, s[24:27], s43 offen offset:1024
    v_mfma_f32_16x16x32_bf16 v[84:87], a[192:195], a[36:39], v[84:87]
    s_add_u32 s55, s55, 18432
    v_pk_max_i16 v64, v64, 0
    v_mfma_f32_16x16x32_bf16 v[88:91], a[192:195], a[40:43], v[88:91]
    v_mul_f32 v98, v98, abs(v98)
    v_mul_f32 v99, v99, abs(v99)
    v_mfma_f32_16x16x32_bf16 v[92:95], a[192:195], a[44:47], v[92:95]
    s_waitcnt vmcnt(16)
    v_mfma_f32_16x16x32_bf16 v[80:83], a[196:199], a[48:51], v[80:83]
    buffer_load_dwordx4 a[192:195], v32, s[24:27], s43 offen offset:2048
    v_mfma_f32_16x16x32_bf16 v[84:87], a[196:199], a[52:55], v[84:87]
    v_cvt_pk_bf16_f32 v65, v98, v99
    v_mfma_f32_16x16x32_bf16 v[88:91], a[196:199], a[56:59], v[88:91]
    v_pk_max_i16 v65, v65, 0
    v_mfma_f32_16x16x32_bf16 v[92:95], a[196:199], a[60:63], v[92:95]
    ds_write_b64 v20, v[64:65] offset:0
    s_waitcnt lgkmcnt(1)
    v_mfma_f32_16x16x16_bf16 v[80:83], v[38:39], v[72:73], v[80:83]
    v_mfma_f32_16x16x16_bf16 v[84:87], v[38:39], v[74:75], v[84:87]
    v_mfma_f32_16x16x16_bf16 v[88:91], v[38:39], v[76:77], v[88:91]
    v_mfma_f32_16x16x16_bf16 v[92:95], v[38:39], v[78:79], v[92:95]
    s_waitcnt vmcnt(16)
    v_mfma_f32_16x16x32_bf16 v[80:83], a[200:203], a[64:67], v[80:83]
    buffer_load_dwordx4 a[196:199], v32, s[24:27], s43 offen offset:3072
    s_add_u32 s43, s43, 4096
    v_mfma_f32_16x16x32_bf16 v[84:87], a[200:203], a[68:71], v[84:87]
    v_mul_f32 v100, v100, abs(v100)
    v_mfma_f32_16x16x32_bf16 v[88:91], a[200:203], a[72:75], v[88:91]
    v_mul_f32 v101, v101, abs(v101)
    v_mfma_f32_16x16x32_bf16 v[92:95], a[200:203], a[76:79], v[92:95]
    v_cvt_pk_bf16_f32 v66, v100, v101
    s_waitcnt vmcnt(16)
    v_mfma_f32_16x16x32_bf16 v[80:83], a[204:207], a[80:83], v[80:83]
    buffer_load_dwordx4 a[200:203], v32, s[24:27], s43 offen offset:0
    v_mfma_f32_16x16x32_bf16 v[84:87], a[204:207], a[84:87], v[84:87]
    v_pk_max_i16 v66, v66, 0
    v_mfma_f32_16x16x32_bf16 v[88:91], a[204:207], a[88:91], v[88:91]
    v_mul_f32 v102, v102, abs(v102)
    v_mfma_f32_16x16x32_bf16 v[92:95], a[204:207], a[92:95], v[92:95]
    v_mul_f32 v103, v103, abs(v103)
    s_waitcnt vmcnt(16)
    v_mfma_f32_16x16x32_bf16 v[80:83], a[208:211], a[96:99], v[80:83]
    buffer_load_dwordx4 a[204:207], v32, s[24:27], s43 offen offset:1024
    v_mfma_f32_16x16x32_bf16 v[84:87], a[208:211], a[100:103], v[84:87]
    v_cvt_pk_bf16_f32 v67, v102, v103
    v_mfma_f32_16x16x32_bf16 v[88:91], a[208:211], a[104:107], v[88:91]
    v_pk_max_i16 v67, v67, 0
    v_mfma_f32_16x16x32_bf16 v[92:95], a[208:211], a[108:111], v[92:95]
    ds_write_b64 v20, v[66:67] offset:1024
    s_waitcnt vmcnt(16)
    v_mfma_f32_16x16x32_bf16 v[80:83], a[212:215], a[112:115], v[80:83]
    buffer_load_dwordx4 a[208:211], v32, s[24:27], s43 offen offset:2048
    v_mfma_f32_16x16x32_bf16 v[84:87], a[212:215], a[116:119], v[84:87]
    v_mul_f32 v104, v104, abs(v104)
    v_mfma_f32_16x16x32_bf16 v[88:91], a[212:215], a[120:123], v[88:91]
    v_mul_f32 v105, v105, abs(v105)
    v_mfma_f32_16x16x32_bf16 v[92:95], a[212:215], a[124:127], v[92:95]
    v_cvt_pk_bf16_f32 v68, v104, v105
    s_waitcnt vmcnt(16)
    v_mfma_f32_16x16x32_bf16 v[80:83], a[216:219], a[128:131], v[80:83]
    buffer_load_dwordx4 a[212:215], v32, s[24:27], s43 offen offset:3072
    s_add_u32 s43, s43, 4096
    v_mfma_f32_16x16x32_bf16 v[84:87], a[216:219], a[132:135], v[84:87]
    v_pk_max_i16 v68, v68, 0
    v_mfma_f32_16x16x32_bf16 v[88:91], a[216:219], a[136:139], v[88:91]
    v_mul_f32 v106, v106, abs(v106)
    v_mfma_f32_16x16x32_bf16 v[92:95], a[216:219], a[140:143], v[92:95]
    v_mul_f32 v107, v107, abs(v107)
    s_waitcnt vmcnt(16)
    v_mfma_f32_16x16x32_bf16 v[80:83], a[220:223], a[144:147], v[80:83]
    buffer_load_dwordx4 a[216:219], v32, s[24:27], s43 offen offset:0
    v_mfma_f32_16x16x32_bf16 v[84:87], a[220:223], a[148:151], v[84:87]
    v_cvt_pk_bf16_f32 v69, v106, v107
    v_mfma_f32_16x16x32_bf16 v[88:91], a[220:223], a[152:155], v[88:91]
    v_pk_max_i16 v69, v69, 0
    v_mfma_f32_16x16x32_bf16 v[92:95], a[220:223], a[156:159], v[92:95]
    ds_write_b64 v20, v[68:69] offset:36864
    s_waitcnt vmcnt(16)
    v_mfma_f32_16x16x32_bf16 v[80:83], a[224:227], a[160:163], v[80:83]
    buffer_load_dwordx4 a[220:223], v32, s[24:27], s43 offen offset:1024
    v_mfma_f32_16x16x32_bf16 v[84:87], a[224:227], a[164:167], v[84:87]
    v_mul_f32 v108, v108, abs(v108)
    v_mfma_f32_16x16x32_bf16 v[88:91], a[224:227], a[168:171], v[88:91]
    v_mul_f32 v109, v109, abs(v109)
    v_mfma_f32_16x16x32_bf16 v[92:95], a[224:227], a[172:175], v[92:95]
    v_cvt_pk_bf16_f32 v70, v108, v109
    s_waitcnt vmcnt(16)
    v_mfma_f32_16x16x32_bf16 v[80:83], a[228:231], a[176:179], v[80:83]
    buffer_load_dwordx4 a[224:227], v32, s[24:27], s43 offen offset:2048
    v_mfma_f32_16x16x32_bf16 v[84:87], a[228:231], a[180:183], v[84:87]
    v_pk_max_i16 v70, v70, 0
    v_mfma_f32_16x16x32_bf16 v[88:91], a[228:231], v[152:155], v[88:91]
    v_mul_f32 v110, v110, abs(v110)
    v_mfma_f32_16x16x32_bf16 v[92:95], a[228:231], v[156:159], v[92:95]
    v_mul_f32 v111, v111, abs(v111)
    s_waitcnt vmcnt(16)
    v_mfma_f32_16x16x32_bf16 v[80:83], a[232:235], v[160:163], v[80:83]
    buffer_load_dwordx4 a[228:231], v32, s[24:27], s43 offen offset:3072
    s_add_u32 s43, s43, 4096
    v_mfma_f32_16x16x32_bf16 v[84:87], a[232:235], v[164:167], v[84:87]
    v_cvt_pk_bf16_f32 v71, v110, v111
    v_mfma_f32_16x16x32_bf16 v[88:91], a[232:235], v[168:171], v[88:91]
    v_pk_max_i16 v71, v71, 0
    v_mfma_f32_16x16x32_bf16 v[92:95], a[232:235], v[172:175], v[92:95]
    ds_write_b64 v20, v[70:71] offset:37888
    s_waitcnt vmcnt(16)
    v_mfma_f32_16x16x32_bf16 v[80:83], a[236:239], v[176:179], v[80:83]
    buffer_load_dwordx4 a[232:235], v32, s[24:27], s43 offen offset:0
    v_mfma_f32_16x16x32_bf16 v[84:87], a[236:239], v[180:183], v[84:87]
    v_add_u32 v20, 4096, v20
    v_mfma_f32_16x16x32_bf16 v[88:91], a[236:239], v[184:187], v[88:91]
    v_mfma_f32_16x16x32_bf16 v[92:95], a[236:239], v[188:191], v[92:95]
    s_waitcnt vmcnt(16)
    v_mfma_f32_16x16x32_bf16 v[80:83], a[240:243], v[192:195], v[80:83]
    buffer_load_dwordx4 a[236:239], v32, s[24:27], s43 offen offset:1024
    v_mfma_f32_16x16x32_bf16 v[84:87], a[240:243], v[196:199], v[84:87]
    v_mfma_f32_16x16x32_bf16 v[88:91], a[240:243], v[200:203], v[88:91]
    v_mfma_f32_16x16x32_bf16 v[92:95], a[240:243], v[204:207], v[92:95]
    s_waitcnt vmcnt(16)
    v_mfma_f32_16x16x32_bf16 v[80:83], a[244:247], v[208:211], v[80:83]
    buffer_load_dwordx4 a[240:243], v32, s[24:27], s43 offen offset:2048
    v_mfma_f32_16x16x32_bf16 v[84:87], a[244:247], v[212:215], v[84:87]
    v_mfma_f32_16x16x32_bf16 v[88:91], a[244:247], v[216:219], v[88:91]
    v_mfma_f32_16x16x32_bf16 v[92:95], a[244:247], v[220:223], v[92:95]
    s_waitcnt vmcnt(16)
    v_mfma_f32_16x16x32_bf16 v[80:83], a[248:251], v[224:227], v[80:83]
    buffer_load_dwordx4 a[244:247], v32, s[24:27], s43 offen offset:3072
    s_add_u32 s43, s43, 4096
    v_mfma_f32_16x16x32_bf16 v[84:87], a[248:251], v[228:231], v[84:87]
    v_mfma_f32_16x16x32_bf16 v[88:91], a[248:251], v[232:235], v[88:91]
    v_mfma_f32_16x16x32_bf16 v[92:95], a[248:251], v[236:239], v[92:95]
    s_waitcnt vmcnt(16)
    v_mfma_f32_16x16x32_bf16 v[80:83], a[252:255], v[240:243], v[80:83]
    buffer_load_dwordx4 a[248:251], v32, s[24:27], s43 offen offset:0
    v_mfma_f32_16x16x32_bf16 v[84:87], a[252:255], v[244:247], v[84:87]
    v_mfma_f32_16x16x32_bf16 v[88:91], a[252:255], v[248:251], v[88:91]
    v_mfma_f32_16x16x32_bf16 v[92:95], a[252:255], v[252:255], v[92:95]
    s_waitcnt lgkmcnt(0)
    s_add_u32 s62, s62, 1
    s_cmp_lt_u32 s62, 3
    s_cbranch_scc1 L_ffn_p1
    s_waitcnt vmcnt(16)
    v_mfma_f32_16x16x32_bf16 v[96:99], a[184:187], a[0:3], 0
    buffer_load_dwordx4 a[252:255], v32, s[24:27], s43 offen offset:1024
    s_mov_b32 s43, s55
    v_mfma_f32_16x16x32_bf16 v[100:103], a[184:187], a[4:7], 0
    v_add_u32 v21, 512, v21
    v_mfma_f32_16x16x32_bf16 v[104:107], a[184:187], a[8:11], 0
    ds_read_b64 v[38:39], v21
    v_mfma_f32_16x16x32_bf16 v[108:111], a[184:187], a[12:15], 0
    s_waitcnt vmcnt(16)
    v_mfma_f32_16x16x32_bf16 v[96:99], a[188:191], a[16:19], v[96:99]
    buffer_load_dwordx4 a[184:187], v32, s[24:27], s43 offen offset:0
    v_mfma_f32_16x16x32_bf16 v[100:103], a[188:191], a[20:23], v[100:103]
    v_mul_f32 v80, v80, abs(v80)
    v_mfma_f32_16x16x32_bf16 v[104:107], a[188:191], a[24:27], v[104:107]
    v_mul_f32 v81, v81, abs(v81)
    v_mfma_f32_16x16x32_bf16 v[108:111], a[188:191], a[28:31], v[108:111]
    v_cvt_pk_bf16_f32 v64, v80, v81
    s_waitcnt vmcnt(16)
    v_mfma_f32_16x16x32_bf16 v[96:99], a[192:195], a[32:35], v[96:99]
    buffer_load_dwordx4 a[188:191], v32, s[24:27], s43 offen offset:1024
    v_mfma_f32_16x16x32_bf16 v[100:103], a[192:195], a[36:39], v[100:103]
    s_add_u32 s55, s54, 147456
    v_pk_max_i16 v64, v64, 0
    v_mfma_f32_16x16x32_bf16 v[104:107], a[192:195], a[40:43], v[104:107]
    v_mul_f32 v82, v82, abs(v82)
    v_mul_f32 v83, v83, abs(v83)
    v_mfma_f32_16x16x32_bf16 v[108:111], a[192:195], a[44:47], v[108:111]
    s_waitcnt vmcnt(16)
    v_mfma_f32_16x16x32_bf16 v[96:99], a[196:199], a[48:51], v[96:99]
    buffer_load_dwordx4 a[192:195], v32, s[24:27], s43 offen offset:2048
    v_mfma_f32_16x16x32_bf16 v[100:103], a[196:199], a[52:55], v[100:103]
    v_cvt_pk_bf16_f32 v65, v82, v83
    v_mfma_f32_16x16x32_bf16 v[104:107], a[196:199], a[56:59], v[104:107]
    v_pk_max_i16 v65, v65, 0
    v_mfma_f32_16x16x32_bf16 v[108:111], a[196:199], a[60:63], v[108:111]
    ds_write_b64 v20, v[64:65] offset:0
    s_waitcnt lgkmcnt(1)
    v_mfma_f32_16x16x16_bf16 v[96:99], v[38:39], v[72:73], v[96:99]
    v_mfma_f32_16x16x16_bf16 v[100:103], v[38:39], v[74:75], v[100:103]
    v_mfma_f32_16x16x16_bf16 v[104:107], v[38:39], v[76:77], v[104:107]
    v_mfma_f32_16x16x16_bf16 v[108:111], v[38:39], v[78:79], v[108:111]
    s_waitcnt vmcnt(16)
    v_mfma_f32_16x16x32_bf16 v[96:99], a[200:203], a[64:67], v[96:99]
    buffer_load_dwordx4 a[196:199], v32, s[24:27], s43 offen offset:3072
    s_add_u32 s43, s43, 4096
    v_mfma_f32_16x16x32_bf16 v[100:103], a[200:203], a[68:71], v[100:103]
    v_mul_f32 v84, v84, abs(v84)
    v_mfma_f32_16x16x32_bf16 v[104:107], a[200:203], a[72:75], v[104:107]
    v_mul_f32 v85, v85, abs(v85)
    v_mfma_f32_16x16x32_bf16 v[108:111], a[200:203], a[76:79], v[108:111]
    v_cvt_pk_bf16_f32 v66, v84, v85
    s_waitcnt vmcnt(16)
    v_mfma_f32_16x16x32_bf16 v[96:99], a[204:207], a[80:83], v[96:99]
    buffer_load_dwordx4 a[200:203], v32, s[24:27], s43 offen offset:0
    v_mfma_f32_16x16x32_bf16 v[100:103], a[204:207], a[84:87], v[100:103]
    v_pk_max_i16 v66, v66, 0
    v_mfma_f32_16x16x32_bf16 v[104:107], a[204:207], a[88:91], v[104:107]
    v_mul_f32 v86, v86, abs(v86)
    v_mfma_f32_16x16x32_bf16 v[108:111], a[204:207], a[92:95], v[108:111]
    v_mul_f32 v87, v87, abs(v87)
    s_waitcnt vmcnt(16)
    v_mfma_f32_16x16x32_bf16 v[96:99], a[208:211], a[96:99], v[96:99]
    buffer_load_dwordx4 a[204:207], v32, s[24:27], s43 offen offset:1024
    v_mfma_f32_16x16x32_bf16 v[100:103], a[208:211], a[100:103], v[100:103]
    v_cvt_pk_bf16_f32 v67, v86, v87
    v_mfma_f32_16x16x32_bf16 v[104:107], a[208:211], a[104:107], v[104:107]
    v_pk_max_i16 v67, v67, 0
    v_mfma_f32_16x16x32_bf16 v[108:111], a[208:211], a[108:111], v[108:111]
    ds_write_b64 v20, v[66:67] offset:1024
    s_waitcnt vmcnt(16)
    v_mfma_f32_16x16x32_bf16 v[96:99], a[212:215], a[112:115], v[96:99]
    buffer_load_dwordx4 a[208:211], v32, s[24:27], s43 offen offset:2048
    v_mfma_f32_16x16x32_bf16 v[100:103], a[212:215], a[116:119], v[100:103]
    v_mul_f32 v88, v88, abs(v88)
    v_mfma_f32_16x16x32_bf16 v[104:107], a[212:215], a[120:123], v[104:107]
    v_mul_f32 v89, v89, abs(v89)
    v_mfma_f32_16x16x32_bf16 v[108:111], a[212:215], a[124:127], v[108:111]
    v_cvt_pk_bf16_f32 v68, v88, v89
    s_waitcnt vmcnt(16)
    v_mfma_f32_16x16x32_bf16 v[96:99], a[216:219], a[128:131], v[96:99]
    buffer_load_dwordx4 a[212:215], v32, s[24:27], s43 offen offset:3072
    s_add_u32 s43, s43, 4096
    v_mfma_f32_16x16x32_bf16 v[100:103], a[216:219], a[132:135], v[100:103]
    v_pk_max_i16 v68, v68, 0
    v_mfma_f32_16x16x32_bf16 v[104:107], a[216:219], a[136:139], v[104:107]
    v_mul_f32 v90, v90, abs(v90)
    v_mfma_f32_16x16x32_bf16 v[108:111], a[216:219], a[140:143], v[108:111]
    v_mul_f32 v91, v91, abs(v91)
    s_waitcnt vmcnt(16)
    v_mfma_f32_16x16x32_bf16 v[96:99], a[220:223], a[144:147], v[96:99]
    buffer_load_dwordx4 a[216:219], v32, s[24:27], s43 offen offset:0
    v_mfma_f32_16x16x32_bf16 v[100:103], a[220:223], a[148:151], v[100:103]
    v_cvt_pk_bf16_f32 v69, v90, v91
    v_mfma_f32_16x16x32_bf16 v[104:107], a[220:223], a[152:155], v[104:107]
    v_pk_max_i16 v69, v69, 0
    v_mfma_f32_16x16x32_bf16 v[108:111], a[220:223], a[156:159], v[108:111]
    ds_write_b64 v20, v[68:69] offset:36864
    s_waitcnt vmcnt(16)
    v_mfma_f32_16x16x32_bf16 v[96:99], a[224:227], a[160:163], v[96:99]
    buffer_load_dwordx4 a[220:223], v32, s[24:27], s43 offen offset:1024
    v_mfma_f32_16x16x32_bf16 v[100:103], a[224:227], a[164:167], v[100:103]
    v_mul_f32 v92, v92, abs(v92)
    v_mfma_f32_16x16x32_bf16 v[104:107], a[224:227], a[168:171], v[104:107]
    v_mul_f32 v93, v93, abs(v93)
    v_mfma_f32_16x16x32_bf16 v[108:111], a[224:227], a[172:175], v[108:111]
    v_cvt_pk_bf16_f32 v70, v92, v93
    s_waitcnt vmcnt(16)
    v_mfma_f32_16x16x32_bf16 v[96:99], a[228:231], a[176:179], v[96:99]
    buffer_load_dwordx4 a[224:227], v32, s[24:27], s43 offen offset:2048
    v_mfma_f32_16x16x32_bf16 v[100:103], a[228:231], a[180:183], v[100:103]
    v_pk_max_i16 v70, v70, 0
    v_mul_f32 v94, v94, abs(v94)
    v_mfma_f32_16x16x32_bf16 v[104:107], a[228:231], v[152:155], v[104:107]
    v_mul_f32 v95, v95, abs(v95)
    v_lshlrev_b32 v5, 2, v4
    v_mfma_f32_16x16x32_bf16 v[108:111], a[228:231], v[156:159], v[108:111]
    v_sub_u32 v5, v3, v5
    s_waitcnt vmcnt(16)
    v_mfma_f32_16x16x32_bf16 v[96:99], a[232:235], v[160:163], v[96:99]
    buffer_load_dwordx4 a[228:231], v32, s[24:27], s43 offen offset:3072
    s_add_u32 s43, s43, 4096
    v_mfma_f32_16x16x32_bf16 v[100:103], a[232:235], v[164:167], v[100:103]
    v_cvt_pk_bf16_f32 v71, v94, v95
    v_pk_max_i16 v71, v71, 0
    v_mfma_f32_16x16x32_bf16 v[104:107], a[232:235], v[168:171], v[104:107]
    ds_write_b64 v20, v[70:71] offset:37888
    v_mov_b32 v6, 0x3f80
    v_mfma_f32_16x16x32_bf16 v[108:111], a[232:235], v[172:175], v[108:111]
    v_mov_b32 v7, 0x3f800000
    s_waitcnt vmcnt(16)
    v_mfma_f32_16x16x32_bf16 v[96:99], a[236:239], v[176:179], v[96:99]
    buffer_load_dwordx4 a[232:235], v32, s[24:27], s43 offen offset:0
    v_mfma_f32_16x16x32_bf16 v[100:103], a[236:239], v[180:183], v[100:103]
    v_add_u32 v20, 4096, v20
    v_mfma_f32_16x16x32_bf16 v[104:107], a[236:239], v[184:187], v[104:107]
    v_mov_b32 v8, 0
    v_mfma_f32_16x16x32_bf16 v[108:111], a[236:239], v[188:191], v[108:111]
    v_mov_b32 v9, 0
    s_waitcnt vmcnt(16)
    v_mfma_f32_16x16x32_bf16 v[96:99], a[240:243], v[192:195], v[96:99]
    buffer_load_dwordx4 a[236:239], v32, s[24:27], s43 offen offset:1024
    v_mfma_f32_16x16x32_bf16 v[100:103], a[240:243], v[196:199], v[100:103]
    v_mov_b32 v12, 0
    v_mfma_f32_16x16x32_bf16 v[104:107], a[240:243], v[200:203], v[104:107]
    v_mov_b32 v13, 0
    v_mfma_f32_16x16x32_bf16 v[108:111], a[240:243], v[204:207], v[108:111]
    s_waitcnt vmcnt(16)
    v_mfma_f32_16x16x32_bf16 v[96:99], a[244:247], v[208:211], v[96:99]
    buffer_load_dwordx4 a[240:243], v32, s[24:27], s43 offen offset:2048
    v_mfma_f32_16x16x32_bf16 v[100:103], a[244:247], v[212:215], v[100:103]
    v_cmp_eq_u32 vcc, 0, v5
    v_cmp_eq_u32 s[48:49], 1, v5
    s_nop 0
    v_cndmask_b32 v10, v14, v6, vcc
    v_cndmask_b32 v10, v10, v7, s[48:49]
    v_mfma_f32_16x16x32_bf16 v[104:107], a[244:247], v[216:219], v[104:107]
    v_cmp_eq_u32 vcc, 2, v5
    v_cmp_eq_u32 s[48:49], 3, v5
    s_nop 0
    v_cndmask_b32 v11, v14, v6, vcc
    v_cndmask_b32 v11, v11, v7, s[48:49]
    v_mfma_f32_16x16x32_bf16 v[108:111], a[244:247], v[220:223], v[108:111]
    s_waitcnt vmcnt(16)
    v_mfma_f32_16x16x32_bf16 v[96:99], a[248:251], v[224:227], v[96:99]
    buffer_load_dwordx4 a[244:247], v32, s[24:27], s43 offen offset:3072
    s_add_u32 s43, s43, 4096
    v_mfma_f32_16x16x32_bf16 v[100:103], a[248:251], v[228:231], v[100:103]
    v_mfma_f32_16x16x32_bf16 v[104:107], a[248:251], v[232:235], v[104:107]
    v_mfma_f32_16x16x32_bf16 v[108:111], a[248:251], v[236:239], v[108:111]
    s_waitcnt vmcnt(16)
    v_mfma_f32_16x16x32_bf16 v[96:99], a[252:255], v[240:243], v[96:99]
    buffer_load_dwordx4 a[248:251], v32, s[24:27], s43 offen offset:0
    v_mfma_f32_16x16x32_bf16 v[100:103], a[252:255], v[244:247], v[100:103]
    v_mfma_f32_16x16x32_bf16 v[104:107], a[252:255], v[248:251], v[104:107]
    v_mfma_f32_16x16x32_bf16 v[108:111], a[252:255], v[252:255], v[108:111]
    s_waitcnt vmcnt(16)
    v_mfma_f32_16x16x32_bf16 v[80:83], a[184:187], a[0:3], 0
    buffer_load_dwordx4 a[252:255], v32, s[24:27], s43 offen offset:1024
    s_mov_b32 s43, s55
    v_mfma_f32_16x16x32_bf16 v[84:87], a[184:187], a[4:7], 0
    s_waitcnt lgkmcnt(0)
    s_barrier
    v_mfma_f32_16x16x32_bf16 v[88:91], a[184:187], a[8:11], 0
    v_add_u32 v21, 512, v21
    v_mfma_f32_16x16x32_bf16 v[92:95], a[184:187], a[12:15], 0
    ds_read_b64 v[38:39], v21
    s_waitcnt vmcnt(16)
    v_mfma_f32_16x16x32_bf16 v[80:83], a[188:191], a[16:19], v[80:83]
    buffer_load_dwordx4 a[184:187], v32, s[24:27], s43 offen offset:0
    v_mul_f32 v96, v96, abs(v96)
    v_mfma_f32_16x16x32_bf16 v[84:87], a[188:191], a[20:23], v[84:87]
    v_mul_f32 v97, v97, abs(v97)
    v_cvt_pk_bf16_f32 v64, v96, v97
    v_mfma_f32_16x16x32_bf16 v[88:91], a[188:191], a[24:27], v[88:91]
    v_pk_max_i16 v64, v64, 0
    v_mul_f32 v98, v98, abs(v98)
    v_mfma_f32_16x16x32_bf16 v[92:95], a[188:191], a[28:31], v[92:95]
    ds_read_b128 a[0:3], v32 offset:0
    ds_read_b128 a[4:7], v32 offset:1024
    ds_read_b128 a[8:11], v33 offset:0
    ds_read_b128 a[12:15], v33 offset:1024
    s_waitcnt vmcnt(16)
    v_mfma_f32_16x16x32_bf16 v[80:83], a[192:195], a[32:35], v[80:83]
    buffer_load_dwordx4 a[188:191], v32, s[24:27], s43 offen offset:1024
    s_add_u32 s52, s52, 1
    s_and_b32 s52, s52, 7
    s_mul_i32 s55, s52, 18432
    s_add_u32 s55, s55, s54
    v_mfma_f32_16x16x32_bf16 v[84:87], a[192:195], a[36:39], v[84:87]
    v_mul_f32 v99, v99, abs(v99)
    v_cvt_pk_bf16_f32 v65, v98, v99
    v_pk_max_i16 v65, v65, 0
    v_mfma_f32_16x16x32_bf16 v[88:91], a[192:195], a[40:43], v[88:91]
    ds_write_b64 v20, v[64:65] offset:0
    v_mul_f32 v100, v100, abs(v100)
    ds_read_b128 a[16:19], v32 offset:2048
    ds_read_b128 a[20:23], v32 offset:3072
    ds_read_b128 a[24:27], v33 offset:2048
    ds_read_b128 a[28:31], v33 offset:3072
    v_mfma_f32_16x16x32_bf16 v[92:95], a[192:195], a[44:47], v[92:95]
    s_waitcnt vmcnt(16)
    v_mfma_f32_16x16x32_bf16 v[80:83], a[196:199], a[48:51], v[80:83]
    buffer_load_dwordx4 a[192:195], v32, s[24:27], s43 offen offset:2048
    v_mul_f32 v101, v101, abs(v101)
    v_mfma_f32_16x16x32_bf16 v[84:87], a[196:199], a[52:55], v[84:87]
    v_cvt_pk_bf16_f32 v66, v100, v101
    v_pk_max_i16 v66, v66, 0
    v_mfma_f32_16x16x32_bf16 v[88:91], a[196:199], a[56:59], v[88:91]
    v_mul_f32 v102, v102, abs(v102)
    v_mul_f32 v103, v103, abs(v103)
    v_mfma_f32_16x16x32_bf16 v[92:95], a[196:199], a[60:63], v[92:95]
    ds_read_b128 a[32:35], v32 offset:4096
    ds_read_b128 a[36:39], v32 offset:5120
    ds_read_b128 a[40:43], v33 offset:4096
    ds_read_b128 a[44:47], v33 offset:5120
    s_waitcnt lgkmcnt(13)
    v_mfma_f32_16x16x16_bf16 v[80:83], v[38:39], v[72:73], v[80:83]
    v_mfma_f32_16x16x16_bf16 v[84:87], v[38:39], v[74:75], v[84:87]
    v_mfma_f32_16x16x16_bf16 v[88:91], v[38:39], v[76:77], v[88:91]
    v_mfma_f32_16x16x16_bf16 v[92:95], v[38:39], v[78:79], v[92:95]
    s_waitcnt vmcnt(16)
    v_mfma_f32_16x16x32_bf16 v[80:83], a[200:203], a[64:67], v[80:83]
    buffer_load_dwordx4 a[196:199], v32, s[24:27], s43 offen offset:3072
    s_add_u32 s43, s43, 4096
    v_cvt_pk_bf16_f32 v67, v102, v103
    v_mfma_f32_16x16x32_bf16 v[84:87], a[200:203], a[68:71], v[84:87]
    v_pk_max_i16 v67, v67, 0
    ds_write_b64 v20, v[66:67] offset:1024
    v_mfma_f32_16x16x32_bf16 v[88:91], a[200:203], a[72:75], v[88:91]
    v_mul_f32 v104, v104, abs(v104)
    v_mul_f32 v105, v105, abs(v105)
    v_mfma_f32_16x16x32_bf16 v[92:95], a[200:203], a[76:79], v[92:95]
    ds_read_b128 a[48:51], v32 offset:6144
    ds_read_b128 a[52:55], v32 offset:7168
    ds_read_b128 a[56:59], v33 offset:6144
    ds_read_b128 a[60:63], v33 offset:7168
    s_waitcnt vmcnt(16)
    v_mfma_f32_16x16x32_bf16 v[80:83], a[204:207], a[80:83], v[80:83]
    buffer_load_dwordx4 a[200:203], v32, s[24:27], s43 offen offset:0
    v_cvt_pk_bf16_f32 v68, v104, v105
    v_mfma_f32_16x16x32_bf16 v[84:87], a[204:207], a[84:87], v[84:87]
    v_pk_max_i16 v68, v68, 0
    v_mul_f32 v106, v106, abs(v106)
    v_mfma_f32_16x16x32_bf16 v[88:91], a[204:207], a[88:91], v[88:91]
    v_mul_f32 v107, v107, abs(v107)
    v_cvt_pk_bf16_f32 v69, v106, v107
    v_mfma_f32_16x16x32_bf16 v[92:95], a[204:207], a[92:95], v[92:95]
    ds_read_b128 a[64:67], v32 offset:8192
    ds_read_b128 a[68:71], v32 offset:9216
    ds_read_b128 a[72:75], v33 offset:8192
    ds_read_b128 a[76:79], v33 offset:9216
    s_waitcnt vmcnt(16)
    v_mfma_f32_16x16x32_bf16 v[80:83], a[208:211], a[96:99], v[80:83]
    buffer_load_dwordx4 a[204:207], v32, s[24:27], s43 offen offset:1024
    v_pk_max_i16 v69, v69, 0
    v_mfma_f32_16x16x32_bf16 v[84:87], a[208:211], a[100:103], v[84:87]
    ds_write_b64 v20, v[68:69] offset:36864
    v_mul_f32 v108, v108, abs(v108)
    v_mfma_f32_16x16x32_bf16 v[88:91], a[208:211], a[104:107], v[88:91]
    v_mul_f32 v109, v109, abs(v109)
    v_cvt_pk_bf16_f32 v70, v108, v109
    v_mfma_f32_16x16x32_bf16 v[92:95], a[208:211], a[108:111], v[92:95]
    ds_read_b128 a[80:83], v32 offset:10240
    ds_read_b128 a[84:87], v32 offset:11264
    ds_read_b128 a[88:91], v33 offset:10240
    ds_read_b128 a[92:95], v33 offset:11264
    s_waitcnt vmcnt(16)
    v_mfma_f32_16x16x32_bf16 v[80:83], a[212:215], a[112:115], v[80:83]
    buffer_load_dwordx4 a[208:211], v32, s[24:27], s43 offen offset:2048
    v_pk_max_i16 v70, v70, 0
    v_mfma_f32_16x16x32_bf16 v[84:87], a[212:215], a[116:119], v[84:87]
    v_mul_f32 v110, v110, abs(v110)
    v_mul_f32 v111, v111, abs(v111)
    v_mfma_f32_16x16x32_bf16 v[88:91], a[212:215], a[120:123], v[88:91]
    v_cvt_pk_bf16_f32 v71, v110, v111
    v_pk_max_i16 v71, v71, 0
    v_mfma_f32_16x16x32_bf16 v[92:95], a[212:215], a[124:127], v[92:95]
    ds_read_b128 a[96:99], v32 offset:12288
    ds_read_b128 a[100:103], v32 offset:13312
    ds_read_b128 a[104:107], v33 offset:12288
    ds_read_b128 a[108:111], v33 offset:13312
    s_waitcnt vmcnt(16)
    v_mfma_f32_16x16x32_bf16 v[80:83], a[216:219], a[128:131], v[80:83]
    buffer_load_dwordx4 a[212:215], v32, s[24:27], s43 offen offset:3072
    s_add_u32 s43, s43, 4096
    v_mfma_f32_16x16x32_bf16 v[84:87], a[216:219], a[132:135], v[84:87]
    ds_write_b64 v20, v[70:71] offset:37888
    v_mfma_f32_16x16x32_bf16 v[88:91], a[216:219], a[136:139], v[88:91]
    v_add_u32 v20, 4096, v20
    v_mfma_f32_16x16x32_bf16 v[92:95], a[216:219], a[140:143], v[92:95]
    ds_read_b128 a[112:115], v32 offset:14336
    ds_read_b128 a[116:119], v32 offset:15360
    ds_read_b128 a[120:123], v33 offset:14336
    ds_read_b128 a[124:127], v33 offset:15360
    s_waitcnt vmcnt(16)
    v_mfma_f32_16x16x32_bf16 v[80:83], a[220:223], a[144:147], v[80:83]
    buffer_load_dwordx4 a[216:219], v32, s[24:27], s43 offen offset:0
    v_mfma_f32_16x16x32_bf16 v[84:87], a[220:223], a[148:151], v[84:87]
    ds_read_b128 a[128:131], v32 offset:16384
    ds_read_b128 a[132:135], v32 offset:17408
    ds_read_b128 a[136:139], v33 offset:16384
    ds_read_b128 a[140:143], v33 offset:17408
    v_mfma_f32_16x16x32_bf16 v[88:91], a[220:223], a[152:155], v[88:91]
    v_mfma_f32_16x16x32_bf16 v[92:95], a[220:223], a[156:159], v[92:95]
    s_waitcnt vmcnt(16)
    v_mfma_f32_16x16x32_bf16 v[80:83], a[224:227], a[160:163], v[80:83]
    buffer_load_dwordx4 a[220:223], v32, s[24:27], s43 offen offset:1024
    v_mfma_f32_16x16x32_bf16 v[84:87], a[224:227], a[164:167], v[84:87]
    ds_read_b128 a[144:147], v32 offset:18432
    ds_read_b128 a[148:151], v32 offset:19456
    ds_read_b128 a[152:155], v33 offset:18432
    ds_read_b128 a[156:159], v33 offset:19456
    v_mfma_f32_16x16x32_bf16 v[88:91], a[224:227], a[168:171], v[88:91]
    v_mfma_f32_16x16x32_bf16 v[92:95], a[224:227], a[172:175], v[92:95]
    s_waitcnt vmcnt(16)
    v_mfma_f32_16x16x32_bf16 v[80:83], a[228:231], a[176:179], v[80:83]
    buffer_load_dwordx4 a[224:227], v32, s[24:27], s43 offen offset:2048
    v_mfma_f32_16x16x32_bf16 v[84:87], a[228:231], a[180:183], v[84:87]
    ds_read_b128 a[160:163], v32 offset:20480
    ds_read_b128 a[164:167], v32 offset:21504
    ds_read_b128 a[168:171], v33 offset:20480
    ds_read_b128 a[172:175], v33 offset:21504
    v_mfma_f32_16x16x32_bf16 v[88:91], a[228:231], v[152:155], v[88:91]
    v_mfma_f32_16x16x32_bf16 v[92:95], a[228:231], v[156:159], v[92:95]
    s_waitcnt vmcnt(16)
    v_mfma_f32_16x16x32_bf16 v[80:83], a[232:235], v[160:163], v[80:83]
    buffer_load_dwordx4 a[228:231], v32, s[24:27], s43 offen offset:3072
    s_add_u32 s43, s43, 4096
    v_mfma_f32_16x16x32_bf16 v[84:87], a[232:235], v[164:167], v[84:87]
    ds_read_b128 a[176:179], v32 offset:22528
    ds_read_b128 a[180:183], v32 offset:23552
    ds_read_b128 v[152:155], v33 offset:22528
    ds_read_b128 v[156:159], v33 offset:23552
    v_mfma_f32_16x16x32_bf16 v[88:91], a[232:235], v[168:171], v[88:91]
    v_mfma_f32_16x16x32_bf16 v[92:95], a[232:235], v[172:175], v[92:95]
    s_waitcnt vmcnt(16)
    v_mfma_f32_16x16x32_bf16 v[80:83], a[236:239], v[176:179], v[80:83]
    buffer_load_dwordx4 a[232:235], v32, s[24:27], s43 offen offset:0
    v_mfma_f32_16x16x32_bf16 v[84:87], a[236:239], v[180:183], v[84:87]
    ds_read_b128 v[160:163], v32 offset:24576
    ds_read_b128 v[164:167], v32 offset:25600
    ds_read_b128 v[168:171], v33 offset:24576
    ds_read_b128 v[172:175], v33 offset:25600
    v_mfma_f32_16x16x32_bf16 v[88:91], a[236:239], v[184:187], v[88:91]
    v_mfma_f32_16x16x32_bf16 v[92:95], a[236:239], v[188:191], v[92:95]
    s_waitcnt vmcnt(16)
    v_mfma_f32_16x16x32_bf16 v[80:83], a[240:243], v[192:195], v[80:83]
    buffer_load_dwordx4 a[236:239], v32, s[24:27], s43 offen offset:1024
    v_mfma_f32_16x16x32_bf16 v[84:87], a[240:243], v[196:199], v[84:87]
    s_waitcnt lgkmcnt(15)
    s_barrier
    v_mfma_f32_16x16x32_bf16 v[88:91], a[240:243], v[200:203], v[88:91]
    ds_read_b128 v[176:179], v32 offset:26624
    ds_read_b128 v[180:183], v32 offset:27648
    ds_read_b128 v[184:187], v33 offset:26624
    ds_read_b128 v[188:191], v33 offset:27648
    v_mfma_f32_16x16x32_bf16 v[92:95], a[240:243], v[204:207], v[92:95]
    s_waitcnt vmcnt(16)
    v_mfma_f32_16x16x32_bf16 v[80:83], a[244:247], v[208:211], v[80:83]
    buffer_load_dwordx4 a[240:243], v32, s[24:27], s43 offen offset:2048
    v_mfma_f32_16x16x32_bf16 v[84:87], a[244:247], v[212:215], v[84:87]
    ds_read_b128 v[192:195], v32 offset:28672
    ds_read_b128 v[196:199], v32 offset:29696
    ds_read_b128 v[200:203], v33 offset:28672
    ds_read_b128 v[204:207], v33 offset:29696
    v_mfma_f32_16x16x32_bf16 v[88:91], a[244:247], v[216:219], v[88:91]
    v_mfma_f32_16x16x32_bf16 v[92:95], a[244:247], v[220:223], v[92:95]
    s_waitcnt vmcnt(16)
    v_mfma_f32_16x16x32_bf16 v[80:83], a[248:251], v[224:227], v[80:83]
    buffer_load_dwordx4 a[244:247], v32, s[24:27], s43 offen offset:3072
    s_add_u32 s43, s43, 4096
    v_mfma_f32_16x16x32_bf16 v[84:87], a[248:251], v[228:231], v[84:87]
    ds_read_b128 v[208:211], v32 offset:30720
    ds_read_b128 v[212:215], v32 offset:31744
    ds_read_b128 v[216:219], v33 offset:30720
    ds_read_b128 v[220:223], v33 offset:31744
    v_mfma_f32_16x16x32_bf16 v[88:91], a[248:251], v[232:235], v[88:91]
    v_mfma_f32_16x16x32_bf16 v[92:95], a[248:251], v[236:239], v[92:95]
    s_waitcnt vmcnt(16)
    v_mfma_f32_16x16x32_bf16 v[80:83], a[252:255], v[240:243], v[80:83]
    buffer_load_dwordx4 a[248:251], v32, s[24:27], s43 offen offset:0
    v_mfma_f32_16x16x32_bf16 v[84:87], a[252:255], v[244:247], v[84:87]
    v_mfma_f32_16x16x32_bf16 v[88:91], a[252:255], v[248:251], v[88:91]
    v_mfma_f32_16x16x32_bf16 v[92:95], a[252:255], v[252:255], v[92:95]
    s_waitcnt vmcnt(16)
    v_mfma_f32_16x16x32_bf16 v[96:99], a[184:187], a[0:3], 0
    buffer_load_dwordx4 a[252:255], v32, s[24:27], s43 offen offset:1024
    s_mov_b32 s43, s55
    v_mfma_f32_16x16x32_bf16 v[100:103], a[184:187], a[4:7], 0
    v_mfma_f32_16x16x32_bf16 v[104:107], a[184:187], a[8:11], 0
    v_mfma_f32_16x16x32_bf16 v[108:111], a[184:187], a[12:15], 0
    s_waitcnt vmcnt(16)
    v_mfma_f32_16x16x32_bf16 v[96:99], a[188:191], a[16:19], v[96:99]
    buffer_load_dwordx4 a[184:187], v32, s[24:27], s43 offen offset:0
    v_mfma_f32_16x16x32_bf16 v[100:103], a[188:191], a[20:23], v[100:103]
    v_mul_f32 v80, v80, abs(v80)
    v_mul_f32 v81, v81, abs(v81)
    v_mfma_f32_16x16x32_bf16 v[104:107], a[188:191], a[24:27], v[104:107]
    v_cvt_pk_bf16_f32 v64, v80, v81
    v_pk_max_i16 v64, v64, 0
    v_mfma_f32_16x16x32_bf16 v[108:111], a[188:191], a[28:31], v[108:111]
    v_mul_f32 v82, v82, abs(v82)
    s_waitcnt vmcnt(16)
    v_mfma_f32_16x16x32_bf16 v[96:99], a[192:195], a[32:35], v[96:99]
    buffer_load_dwordx4 a[188:191], v32, s[24:27], s43 offen offset:1024
    s_add_u32 s52, s52, 1
    s_and_b32 s52, s52, 7
    s_mul_i32 s55, s52, 18432
    s_add_u32 s55, s55, s54
    v_mfma_f32_16x16x32_bf16 v[100:103], a[192:195], a[36:39], v[100:103]
    v_mul_f32 v83, v83, abs(v83)
    v_cvt_pk_bf16_f32 v65, v82, v83
    v_mfma_f32_16x16x32_bf16 v[104:107], a[192:195], a[40:43], v[104:107]
    v_pk_max_i16 v65, v65, 0
    ds_write_b64 v20, v[64:65] offset:0
    v_mfma_f32_16x16x32_bf16 v[108:111], a[192:195], a[44:47], v[108:111]
    v_mul_f32 v84, v84, abs(v84)
    s_waitcnt vmcnt(16)
    v_mfma_f32_16x16x32_bf16 v[96:99], a[196:199], a[48:51], v[96:99]
    buffer_load_dwordx4 a[192:195], v32, s[24:27], s43 offen offset:2048
    v_mfma_f32_16x16x32_bf16 v[100:103], a[196:199], a[52:55], v[100:103]
    v_mul_f32 v85, v85, abs(v85)
    v_cvt_pk_bf16_f32 v66, v84, v85
    v_mfma_f32_16x16x32_bf16 v[104:107], a[196:199], a[56:59], v[104:107]
    v_pk_max_i16 v66, v66, 0
    v_mul_f32 v86, v86, abs(v86)
    v_mfma_f32_16x16x32_bf16 v[108:111], a[196:199], a[60:63], v[108:111]
    v_mul_f32 v87, v87, abs(v87)
    s_waitcnt vmcnt(16)
    v_mfma_f32_16x16x32_bf16 v[96:99], a[200:203], a[64:67], v[96:99]
    buffer_load_dwordx4 a[196:199], v32, s[24:27], s43 offen offset:3072
    s_add_u32 s43, s43, 4096
    v_mfma_f32_16x16x32_bf16 v[100:103], a[200:203], a[68:71], v[100:103]
    v_cvt_pk_bf16_f32 v67, v86, v87
    v_pk_max_i16 v67, v67, 0
    v_mfma_f32_16x16x32_bf16 v[104:107], a[200:203], a[72:75], v[104:107]
    ds_write_b64 v20, v[66:67] offset:1024
    v_mul_f32 v88, v88, abs(v88)
    v_mfma_f32_16x16x32_bf16 v[108:111], a[200:203], a[76:79], v[108:111]
    v_mul_f32 v89, v89, abs(v89)
    s_waitcnt vmcnt(16)
    v_mfma_f32_16x16x32_bf16 v[96:99], a[204:207], a[80:83], v[96:99]
    buffer_load_dwordx4 a[200:203], v32, s[24:27], s43 offen offset:0
    v_mfma_f32_16x16x32_bf16 v[100:103], a[204:207], a[84:87], v[100:103]
    v_cvt_pk_bf16_f32 v68, v88, v89
    v_pk_max_i16 v68, v68, 0
    v_mfma_f32_16x16x32_bf16 v[104:107], a[204:207], a[88:91], v[104:107]
    v_mul_f32 v90, v90, abs(v90)
    v_mul_f32 v91, v91, abs(v91)
    v_mfma_f32_16x16x32_bf16 v[108:111], a[204:207], a[92:95], v[108:111]
    v_cvt_pk_bf16_f32 v69, v90, v91
    s_waitcnt vmcnt(16)
    v_mfma_f32_16x16x32_bf16 v[96:99], a[208:211], a[96:99], v[96:99]
    buffer_load_dwordx4 a[204:207], v32, s[24:27], s43 offen offset:1024
    v_mfma_f32_16x16x32_bf16 v[100:103], a[208:211], a[100:103], v[100:103]
    v_pk_max_i16 v69, v69, 0
    ds_write_b64 v20, v[68:69] offset:36864
    v_mfma_f32_16x16x32_bf16 v[104:107], a[208:211], a[104:107], v[104:107]
    v_mul_f32 v92, v92, abs(v92)
    v_mul_f32 v93, v93, abs(v93)
    v_mfma_f32_16x16x32_bf16 v[108:111], a[208:211], a[108:111], v[108:111]
    v_cvt_pk_bf16_f32 v70, v92, v93
    s_waitcnt vmcnt(16)
    v_mfma_f32_16x16x32_bf16 v[96:99], a[212:215], a[112:115], v[96:99]
    buffer_load_dwordx4 a[208:211], v32, s[24:27], s43 offen offset:2048
    v_mfma_f32_16x16x32_bf16 v[100:103], a[212:215], a[116:119], v[100:103]
    v_pk_max_i16 v70, v70, 0
    v_mul_f32 v94, v94, abs(v94)
    v_mfma_f32_16x16x32_bf16 v[104:107], a[212:215], a[120:123], v[104:107]
    v_mul_f32 v95, v95, abs(v95)
    v_cvt_pk_bf16_f32 v71, v94, v95
    v_mfma_f32_16x16x32_bf16 v[108:111], a[212:215], a[124:127], v[108:111]
    v_pk_max_i16 v71, v71, 0
    s_waitcnt vmcnt(16)
    v_mfma_f32_16x16x32_bf16 v[96:99], a[216:219], a[128:131], v[96:99]
    buffer_load_dwordx4 a[212:215], v32, s[24:27], s43 offen offset:3072
    s_add_u32 s43, s43, 4096
    v_mfma_f32_16x16x32_bf16 v[100:103], a[216:219], a[132:135], v[100:103]
    ds_write_b64 v20, v[70:71] offset:37888
    v_mfma_f32_16x16x32_bf16 v[104:107], a[216:219], a[136:139], v[104:107]
    v_add_u32 v20, 4096, v20
    v_mfma_f32_16x16x32_bf16 v[108:111], a[216:219], a[140:143], v[108:111]
    s_waitcnt vmcnt(16)
    s_waitcnt lgkmcnt(15)
    v_mfma_f32_16x16x32_bf16 v[96:99], a[220:223], a[144:147], v[96:99]
    buffer_load_dwordx4 a[216:219], v32, s[24:27], s43 offen offset:0
    v_mfma_f32_16x16x32_bf16 v[100:103], a[220:223], a[148:151], v[100:103]
    v_mfma_f32_16x16x32_bf16 v[104:107], a[220:223], a[152:155], v[104:107]
    v_mfma_f32_16x16x32_bf16 v[108:111], a[220:223], a[156:159], v[108:111]
    s_waitcnt vmcnt(16)
    v_mfma_f32_16x16x32_bf16 v[96:99], a[224:227], a[160:163], v[96:99]
    buffer_load_dwordx4 a[220:223], v32, s[24:27], s43 offen offset:1024
    v_mfma_f32_16x16x32_bf16 v[100:103], a[224:227], a[164:167], v[100:103]
    s_waitcnt lgkmcnt(0)
    s_barrier
    v_mfma_f32_16x16x32_bf16 v[104:107], a[224:227], a[168:171], v[104:107]
    v_mfma_f32_16x16x32_bf16 v[108:111], a[224:227], a[172:175], v[108:111]
    s_waitcnt vmcnt(16)
    v_mfma_f32_16x16x32_bf16 v[96:99], a[228:231], a[176:179], v[96:99]
    buffer_load_dwordx4 a[224:227], v32, s[24:27], s43 offen offset:2048
    v_mfma_f32_16x16x32_bf16 v[100:103], a[228:231], a[180:183], v[100:103]
    ds_read_b128 v[224:227], v32 offset:32768
    ds_read_b128 v[228:231], v32 offset:33792
    ds_read_b128 v[232:235], v33 offset:32768
    ds_read_b128 v[236:239], v33 offset:33792
    v_mfma_f32_16x16x32_bf16 v[104:107], a[228:231], v[152:155], v[104:107]
    v_mfma_f32_16x16x32_bf16 v[108:111], a[228:231], v[156:159], v[108:111]
    s_waitcnt vmcnt(16)
    v_mfma_f32_16x16x32_bf16 v[96:99], a[232:235], v[160:163], v[96:99]
    buffer_load_dwordx4 a[228:231], v32, s[24:27], s43 offen offset:3072
    s_add_u32 s43, s43, 4096
    v_mfma_f32_16x16x32_bf16 v[100:103], a[232:235], v[164:167], v[100:103]
    ds_read_b128 v[240:243], v32 offset:34816
    ds_read_b128 v[244:247], v32 offset:35840
    ds_read_b128 v[248:251], v33 offset:34816
    ds_read_b128 v[252:255], v33 offset:35840
    v_mfma_f32_16x16x32_bf16 v[104:107], a[232:235], v[168:171], v[104:107]
    v_mfma_f32_16x16x32_bf16 v[108:111], a[232:235], v[172:175], v[108:111]
    s_waitcnt vmcnt(16)
    v_mfma_f32_16x16x32_bf16 v[96:99], a[236:239], v[176:179], v[96:99]
    buffer_load_dwordx4 a[232:235], v32, s[24:27], s43 offen offset:0
    v_mfma_f32_16x16x32_bf16 v[100:103], a[236:239], v[180:183], v[100:103]
    v_mfma_f32_16x16x32_bf16 v[104:107], a[236:239], v[184:187], v[104:107]
    v_mfma_f32_16x16x32_bf16 v[108:111], a[236:239], v[188:191], v[108:111]
    s_waitcnt vmcnt(16)
    v_mfma_f32_16x16x32_bf16 v[96:99], a[240:243], v[192:195], v[96:99]
    buffer_load_dwordx4 a[236:239], v32, s[24:27], s43 offen offset:1024
    v_mfma_f32_16x16x32_bf16 v[100:103], a[240:243], v[196:199], v[100:103]
    v_mfma_f32_16x16x32_bf16 v[104:107], a[240:243], v[200:203], v[104:107]
    v_mfma_f32_16x16x32_bf16 v[108:111], a[240:243], v[204:207], v[108:111]
    s_waitcnt vmcnt(16)
    v_mfma_f32_16x16x32_bf16 v[96:99], a[244:247], v[208:211], v[96:99]
    buffer_load_dwordx4 a[240:243], v32, s[24:27], s43 offen offset:2048
    v_mfma_f32_16x16x32_bf16 v[100:103], a[244:247], v[212:215], v[100:103]
    v_mfma_f32_16x16x32_bf16 v[104:107], a[244:247], v[216:219], v[104:107]
    v_mfma_f32_16x16x32_bf16 v[108:111], a[244:247], v[220:223], v[108:111]
    s_waitcnt vmcnt(16)
    s_waitcnt lgkmcnt(4)
    v_mfma_f32_16x16x32_bf16 v[96:99], a[248:251], v[224:227], v[96:99]
    buffer_load_dwordx4 a[244:247], v32, s[24:27], s43 offen offset:3072
    s_add_u32 s43, s43, 4096
    v_mfma_f32_16x16x32_bf16 v[100:103], a[248:251], v[228:231], v[100:103]
    v_mfma_f32_16x16x32_bf16 v[104:107], a[248:251], v[232:235], v[104:107]
    v_mfma_f32_16x16x32_bf16 v[108:111], a[248:251], v[236:239], v[108:111]
    s_waitcnt vmcnt(16)
    s_waitcnt lgkmcnt(0)
    v_mfma_f32_16x16x32_bf16 v[96:99], a[252:255], v[240:243], v[96:99]
    buffer_load_dwordx4 a[248:251], v32, s[24:27], s43 offen offset:0
    v_mfma_f32_16x16x32_bf16 v[100:103], a[252:255], v[244:247], v[100:103]
    v_mfma_f32_16x16x32_bf16 v[104:107], a[252:255], v[248:251], v[104:107]
    v_mfma_f32_16x16x32_bf16 v[108:111], a[252:255], v[252:255], v[108:111]
    s_mov_b32 s62, 0
L_ffn_p2:
    s_waitcnt vmcnt(16)
    v_mfma_f32_16x16x32_bf16 v[80:83], a[184:187], a[0:3], 0
    buffer_load_dwordx4 a[252:255], v32, s[24:27], s43 offen offset:1024
    s_mov_b32 s43, s55
    v_mfma_f32_16x16x32_bf16 v[84:87], a[184:187], a[4:7], 0
    v_mfma_f32_16x16x32_bf16 v[88:91], a[184:187], a[8:11], 0
    v_mfma_f32_16x16x32_bf16 v[92:95], a[184:187], a[12:15], 0
    s_waitcnt vmcnt(16)
    v_mfma_f32_16x16x32_bf16 v[80:83], a[188:191], a[16:19], v[80:83]
    buffer_load_dwordx4 a[184:187], v32, s[24:27], s43 offen offset:0
    v_mfma_f32_16x16x32_bf16 v[84:87], a[188:191], a[20:23], v[84:87]
    v_cvt_pk_bf16_f32 v64, v96, v97
    v_cvt_pk_bf16_f32 v65, v98, v99
    v_mfma_f32_16x16x32_bf16 v[88:91], a[188:191], a[24:27], v[88:91]
    v_cvt_pk_bf16_f32 v66, v100, v101
    v_cvt_pk_bf16_f32 v67, v102, v103
    v_mfma_f32_16x16x32_bf16 v[92:95], a[188:191], a[28:31], v[92:95]
    s_waitcnt vmcnt(16)
    v_mfma_f32_16x16x32_bf16 v[80:83], a[192:195], a[32:35], v[80:83]
    buffer_load_dwordx4 a[188:191], v32, s[24:27], s43 offen offset:1024
    v_mfma_f32_16x16x32_bf16 v[84:87], a[192:195], a[36:39], v[84:87]
    s_add_u32 s52, s52, 1
    s_and_b32 s52, s52, 7
    s_mul_i32 s55, s52, 18432
    s_add_u32 s55, s55, s54
    v_cvt_pk_bf16_f32 v68, v104, v105
    v_mfma_f32_16x16x32_bf16 v[88:91], a[192:195], a[40:43], v[88:91]
    v_cvt_pk_bf16_f32 v69, v106, v107
    v_cvt_pk_bf16_f32 v70, v108, v109
    v_mfma_f32_16x16x32_bf16 v[92:95], a[192:195], a[44:47], v[92:95]
    v_cvt_pk_bf16_f32 v71, v110, v111
    s_waitcnt vmcnt(16)
    v_mfma_f32_16x16x32_bf16 v[80:83], a[196:199], a[48:51], v[80:83]
    buffer_load_dwordx4 a[192:195], v32, s[24:27], s43 offen offset:2048
    v_mfma_f32_16x16x32_bf16 v[84:87], a[196:199], a[52:55], v[84:87]
    s_nop 0
    v_mfma_f32_16x16x32_bf16 v[88:91], a[196:199], a[56:59], v[88:91]
    s_add_u32 s72, s68, s63
    s_mov_b64 exec, 1
    buffer_store_dword v15, v14, s[24:27], s72 offen sc1
    s_mov_b64 exec, -1
    v_mfma_f32_16x16x32_bf16 v[92:95], a[196:199], a[60:63], v[92:95]
    s_lshl_b32 s72, s71, 6
    s_add_u32 s72, s72, s60
    buffer_store_dwordx4 v[64:67], v32, s[24:27], s72 offen sc1
    buffer_store_dwordx4 v[68:71], v32, s[24:27], s72 offen offset:1024 sc1
    s_mov_b32 s63, s71
    s_add_u32 s69, s69, 128
    s_and_b32 s69, s69, 1023
    s_mov_b32 s71, s69
    s_waitcnt vmcnt(16)
    v_mfma_f32_16x16x32_bf16 v[80:83], a[200:203], a[64:67], v[80:83]
    buffer_load_dwordx4 a[196:199], v32, s[24:27], s43 offen offset:3072
    s_add_u32 s43, s43, 4096
    v_mfma_f32_16x16x32_bf16 v[84:87], a[200:203], a[68:71], v[84:87]
    v_mfma_f32_16x16x32_bf16 v[88:91], a[200:203], a[72:75], v[88:91]
    v_mfma_f32_16x16x32_bf16 v[92:95], a[200:203], a[76:79], v[92:95]
    s_waitcnt vmcnt(16)
    v_mfma_f32_16x16x32_bf16 v[80:83], a[204:207], a[80:83], v[80:83]
    buffer_load_dwordx4 a[200:203], v32, s[24:27], s43 offen offset:0
    v_mfma_f32_16x16x32_bf16 v[84:87], a[204:207], a[84:87], v[84:87]
    v_mfma_f32_16x16x32_bf16 v[88:91], a[204:207], a[88:91], v[88:91]
    v_mfma_f32_16x16x32_bf16 v[92:95], a[204:207], a[92:95], v[92:95]
    s_waitcnt vmcnt(16)
    v_mfma_f32_16x16x32_bf16 v[80:83], a[208:211], a[96:99], v[80:83]
    buffer_load_dwordx4 a[204:207], v32, s[24:27], s43 offen offset:1024
    v_mfma_f32_16x16x32_bf16 v[84:87], a[208:211], a[100:103], v[84:87]
    v_mfma_f32_16x16x32_bf16 v[88:91], a[208:211], a[104:107], v[88:91]
    v_mfma_f32_16x16x32_bf16 v[92:95], a[208:211], a[108:111], v[92:95]
    s_waitcnt vmcnt(16)
    v_mfma_f32_16x16x32_bf16 v[80:83], a[212:215], a[112:115], v[80:83]
    buffer_load_dwordx4 a[208:211], v32, s[24:27], s43 offen offset:2048
    v_mfma_f32_16x16x32_bf16 v[84:87], a[212:215], a[116:119], v[84:87]
    v_mfma_f32_16x16x32_bf16 v[88:91], a[212:215], a[120:123], v[88:91]
    v_mfma_f32_16x16x32_bf16 v[92:95], a[212:215], a[124:127], v[92:95]
    s_waitcnt vmcnt(16)
    v_mfma_f32_16x16x32_bf16 v[80:83], a[216:219], a[128:131], v[80:83]
    buffer_load_dwordx4 a[212:215], v32, s[24:27], s43 offen offset:3072
    s_add_u32 s43, s43, 4096
    v_mfma_f32_16x16x32_bf16 v[84:87], a[216:219], a[132:135], v[84:87]
    v_mfma_f32_16x16x32_bf16 v[88:91], a[216:219], a[136:139], v[88:91]
    v_mfma_f32_16x16x32_bf16 v[92:95], a[216:219], a[140:143], v[92:95]
    s_waitcnt vmcnt(16)
    v_mfma_f32_16x16x32_bf16 v[80:83], a[220:223], a[144:147], v[80:83]
    buffer_load_dwordx4 a[216:219], v32, s[24:27], s43 offen offset:0
    v_mfma_f32_16x16x32_bf16 v[84:87], a[220:223], a[148:151], v[84:87]
    v_mfma_f32_16x16x32_bf16 v[88:91], a[220:223], a[152:155], v[88:91]
    v_mfma_f32_16x16x32_bf16 v[92:95], a[220:223], a[156:159], v[92:95]
    s_waitcnt vmcnt(16)
    v_mfma_f32_16x16x32_bf16 v[80:83], a[224:227], a[160:163], v[80:83]
    buffer_load_dwordx4 a[220:223], v32, s[24:27], s43 offen offset:1024
    v_mfma_f32_16x16x32_bf16 v[84:87], a[224:227], a[164:167], v[84:87]
    v_mfma_f32_16x16x32_bf16 v[88:91], a[224:227], a[168:171], v[88:91]
    v_mfma_f32_16x16x32_bf16 v[92:95], a[224:227], a[172:175], v[92:95]
    s_waitcnt vmcnt(16)
    v_mfma_f32_16x16x32_bf16 v[80:83], a[228:231], a[176:179], v[80:83]
    buffer_load_dwordx4 a[224:227], v32, s[24:27], s43 offen offset:2048
    v_mfma_f32_16x16x32_bf16 v[84:87], a[228:231], a[180:183], v[84:87]
    v_mfma_f32_16x16x32_bf16 v[88:91], a[228:231], v[152:155], v[88:91]
    v_mfma_f32_16x16x32_bf16 v[92:95], a[228:231], v[156:159], v[92:95]
    s_waitcnt vmcnt(16)
    v_mfma_f32_16x16x32_bf16 v[80:83], a[232:235], v[160:163], v[80:83]
    buffer_load_dwordx4 a[228:231], v32, s[24:27], s43 offen offset:3072
    s_add_u32 s43, s43, 4096
    v_mfma_f32_16x16x32_bf16 v[84:87], a[232:235], v[164:167], v[84:87]
    v_mfma_f32_16x16x32_bf16 v[88:91], a[232:235], v[168:171], v[88:91]
    v_mfma_f32_16x16x32_bf16 v[92:95], a[232:235], v[172:175], v[92:95]
    s_waitcnt vmcnt(16)
    v_mfma_f32_16x16x32_bf16 v[80:83], a[236:239], v[176:179], v[80:83]
    buffer_load_dwordx4 a[232:235], v32, s[24:27], s43 offen offset:0
    v_mfma_f32_16x16x32_bf16 v[84:87], a[236:239], v[180:183], v[84:87]
    v_mfma_f32_16x16x32_bf16 v[88:91], a[236:239], v[184:187], v[88:91]
    v_mfma_f32_16x16x32_bf16 v[92:95], a[236:239], v[188:191], v[92:95]
    s_waitcnt vmcnt(16)
    v_mfma_f32_16x16x32_bf16 v[80:83], a[240:243], v[192:195], v[80:83]
    buffer_load_dwordx4 a[236:239], v32, s[24:27], s43 offen offset:1024
    v_mfma_f32_16x16x32_bf16 v[84:87], a[240:243], v[196:199], v[84:87]
    v_mfma_f32_16x16x32_bf16 v[88:91], a[240:243], v[200:203], v[88:91]
    v_mfma_f32_16x16x32_bf16 v[92:95], a[240:243], v[204:207], v[92:95]
    s_waitcnt vmcnt(16)
    v_mfma_f32_16x16x32_bf16 v[80:83], a[244:247], v[208:211], v[80:83]
    buffer_load_dwordx4 a[240:243], v32, s[24:27], s43 offen offset:2048
    v_mfma_f32_16x16x32_bf16 v[84:87], a[244:247], v[212:215], v[84:87]
    v_mfma_f32_16x16x32_bf16 v[88:91], a[244:247], v[216:219], v[88:91]
    v_mfma_f32_16x16x32_bf16 v[92:95], a[244:247], v[220:223], v[92:95]
    s_waitcnt vmcnt(16)
    v_mfma_f32_16x16x32_bf16 v[80:83], a[248:251], v[224:227], v[80:83]
    buffer_load_dwordx4 a[244:247], v32, s[24:27], s43 offen offset:3072
    s_add_u32 s43, s43, 4096
    v_mfma_f32_16x16x32_bf16 v[84:87], a[248:251], v[228:231], v[84:87]
    v_mfma_f32_16x16x32_bf16 v[88:91], a[248:251], v[232:235], v[88:91]
    v_mfma_f32_16x16x32_bf16 v[92:95], a[248:251], v[236:239], v[92:95]
    s_waitcnt vmcnt(16)
    v_mfma_f32_16x16x32_bf16 v[80:83], a[252:255], v[240:243], v[80:83]
    buffer_load_dwordx4 a[248:251], v32, s[24:27], s43 offen offset:0
    v_mfma_f32_16x16x32_bf16 v[84:87], a[252:255], v[244:247], v[84:87]
    v_mfma_f32_16x16x32_bf16 v[88:91], a[252:255], v[248:251], v[88:91]
    v_mfma_f32_16x16x32_bf16 v[92:95], a[252:255], v[252:255], v[92:95]
    s_waitcnt vmcnt(16)
    v_mfma_f32_16x16x32_bf16 v[96:99], a[184:187], a[0:3], 0
    buffer_load_dwordx4 a[252:255], v32, s[24:27], s43 offen offset:1024
    s_mov_b32 s43, s55
    v_mfma_f32_16x16x32_bf16 v[100:103], a[184:187], a[4:7], 0
    v_mfma_f32_16x16x32_bf16 v[104:107], a[184:187], a[8:11], 0
    v_mfma_f32_16x16x32_bf16 v[108:111], a[184:187], a[12:15], 0
    s_waitcnt vmcnt(16)
    v_mfma_f32_16x16x32_bf16 v[96:99], a[188:191], a[16:19], v[96:99]
    buffer_load_dwordx4 a[184:187], v32, s[24:27], s43 offen offset:0
    v_mfma_f32_16x16x32_bf16 v[100:103], a[188:191], a[20:23], v[100:103]
    v_cvt_pk_bf16_f32 v64, v80, v81
    v_cvt_pk_bf16_f32 v65, v82, v83
    v_mfma_f32_16x16x32_bf16 v[104:107], a[188:191], a[24:27], v[104:107]
    v_cvt_pk_bf16_f32 v66, v84, v85
    v_cvt_pk_bf16_f32 v67, v86, v87
    v_mfma_f32_16x16x32_bf16 v[108:111], a[188:191], a[28:31], v[108:111]
    s_waitcnt vmcnt(16)
    v_mfma_f32_16x16x32_bf16 v[96:99], a[192:195], a[32:35], v[96:99]
    buffer_load_dwordx4 a[188:191], v32, s[24:27], s43 offen offset:1024
    v_mfma_f32_16x16x32_bf16 v[100:103], a[192:195], a[36:39], v[100:103]
    s_add_u32 s52, s52, 1
    s_and_b32 s52, s52, 7
    s_mul_i32 s55, s52, 18432
    s_add_u32 s55, s55, s54
    v_cvt_pk_bf16_f32 v68, v88, v89
    v_mfma_f32_16x16x32_bf16 v[104:107], a[192:195], a[40:43], v[104:107]
    v_cvt_pk_bf16_f32 v69, v90, v91
    v_cvt_pk_bf16_f32 v70, v92, v93
    v_mfma_f32_16x16x32_bf16 v[108:111], a[192:195], a[44:47], v[108:111]
    v_cvt_pk_bf16_f32 v71, v94, v95
    s_waitcnt vmcnt(16)
    v_mfma_f32_16x16x32_bf16 v[96:99], a[196:199], a[48:51], v[96:99]
    buffer_load_dwordx4 a[192:195], v32, s[24:27], s43 offen offset:2048
    v_mfma_f32_16x16x32_bf16 v[100:103], a[196:199], a[52:55], v[100:103]
    s_nop 0
    v_mfma_f32_16x16x32_bf16 v[104:107], a[196:199], a[56:59], v[104:107]
    s_add_u32 s72, s68, s63
    s_mov_b64 exec, 1
    buffer_store_dword v15, v14, s[24:27], s72 offen sc1
    s_mov_b64 exec, -1
    v_mfma_f32_16x16x32_bf16 v[108:111], a[196:199], a[60:63], v[108:111]
    s_lshl_b32 s72, s71, 6
    s_add_u32 s72, s72, s60
    buffer_store_dwordx4 v[64:67], v32, s[24:27], s72 offen sc1
    buffer_store_dwordx4 v[68:71], v32, s[24:27], s72 offen offset:1024 sc1
    s_mov_b32 s63, s71
    s_add_u32 s69, s69, 128
    s_and_b32 s69, s69, 1023
    s_mov_b32 s71, s69
    s_waitcnt vmcnt(16)
    v_mfma_f32_16x16x32_bf16 v[96:99], a[200:203], a[64:67], v[96:99]
    buffer_load_dwordx4 a[196:199], v32, s[24:27], s43 offen offset:3072
    s_add_u32 s43, s43, 4096
    v_mfma_f32_16x16x32_bf16 v[100:103], a[200:203], a[68:71], v[100:103]
    v_mfma_f32_16x16x32_bf16 v[104:107], a[200:203], a[72:75], v[104:107]
    v_mfma_f32_16x16x32_bf16 v[108:111], a[200:203], a[76:79], v[108:111]
    s_waitcnt vmcnt(16)
    v_mfma_f32_16x16x32_bf16 v[96:99], a[204:207], a[80:83], v[96:99]
    buffer_load_dwordx4 a[200:203], v32, s[24:27], s43 offen offset:0
    v_mfma_f32_16x16x32_bf16 v[100:103], a[204:207], a[84:87], v[100:103]
    v_mfma_f32_16x16x32_bf16 v[104:107], a[204:207], a[88:91], v[104:107]
    v_mfma_f32_16x16x32_bf16 v[108:111], a[204:207], a[92:95], v[108:111]
    s_waitcnt vmcnt(16)
    v_mfma_f32_16x16x32_bf16 v[96:99], a[208:211], a[96:99], v[96:99]
    buffer_load_dwordx4 a[204:207], v32, s[24:27], s43 offen offset:1024
    v_mfma_f32_16x16x32_bf16 v[100:103], a[208:211], a[100:103], v[100:103]
    v_mfma_f32_16x16x32_bf16 v[104:107], a[208:211], a[104:107], v[104:107]
    v_mfma_f32_16x16x32_bf16 v[108:111], a[208:211], a[108:111], v[108:111]
    s_waitcnt vmcnt(16)
    v_mfma_f32_16x16x32_bf16 v[96:99], a[212:215], a[112:115], v[96:99]
    buffer_load_dwordx4 a[208:211], v32, s[24:27], s43 offen offset:2048
    v_mfma_f32_16x16x32_bf16 v[100:103], a[212:215], a[116:119], v[100:103]
    v_mfma_f32_16x16x32_bf16 v[104:107], a[212:215], a[120:123], v[104:107]
    v_mfma_f32_16x16x32_bf16 v[108:111], a[212:215], a[124:127], v[108:111]
    s_waitcnt vmcnt(16)
    v_mfma_f32_16x16x32_bf16 v[96:99], a[216:219], a[128:131], v[96:99]
    buffer_load_dwordx4 a[212:215], v32, s[24:27], s43 offen offset:3072
    s_add_u32 s43, s43, 4096
    v_mfma_f32_16x16x32_bf16 v[100:103], a[216:219], a[132:135], v[100:103]
    v_mfma_f32_16x16x32_bf16 v[104:107], a[216:219], a[136:139], v[104:107]
    v_mfma_f32_16x16x32_bf16 v[108:111], a[216:219], a[140:143], v[108:111]
    s_waitcnt vmcnt(16)
    v_mfma_f32_16x16x32_bf16 v[96:99], a[220:223], a[144:147], v[96:99]
    buffer_load_dwordx4 a[216:219], v32, s[24:27], s43 offen offset:0
    v_mfma_f32_16x16x32_bf16 v[100:103], a[220:223], a[148:151], v[100:103]
    v_mfma_f32_16x16x32_bf16 v[104:107], a[220:223], a[152:155], v[104:107]
    v_mfma_f32_16x16x32_bf16 v[108:111], a[220:223], a[156:159], v[108:111]
    s_waitcnt vmcnt(16)
    v_mfma_f32_16x16x32_bf16 v[96:99], a[224:227], a[160:163], v[96:99]
    buffer_load_dwordx4 a[220:223], v32, s[24:27], s43 offen offset:1024
    v_mfma_f32_16x16x32_bf16 v[100:103], a[224:227], a[164:167], v[100:103]
    v_mfma_f32_16x16x32_bf16 v[104:107], a[224:227], a[168:171], v[104:107]
    v_mfma_f32_16x16x32_bf16 v[108:111], a[224:227], a[172:175], v[108:111]
    s_waitcnt vmcnt(16)
    v_mfma_f32_16x16x32_bf16 v[96:99], a[228:231], a[176:179], v[96:99]
    buffer_load_dwordx4 a[224:227], v32, s[24:27], s43 offen offset:2048
    v_mfma_f32_16x16x32_bf16 v[100:103], a[228:231], a[180:183], v[100:103]
    v_mfma_f32_16x16x32_bf16 v[104:107], a[228:231], v[152:155], v[104:107]
    v_mfma_f32_16x16x32_bf16 v[108:111], a[228:231], v[156:159], v[108:111]
    s_waitcnt vmcnt(16)
    v_mfma_f32_16x16x32_bf16 v[96:99], a[232:235], v[160:163], v[96:99]
    buffer_load_dwordx4 a[228:231], v32, s[24:27], s43 offen offset:3072
    s_add_u32 s43, s43, 4096
    v_mfma_f32_16x16x32_bf16 v[100:103], a[232:235], v[164:167], v[100:103]
    v_mfma_f32_16x16x32_bf16 v[104:107], a[232:235], v[168:171], v[104:107]
    v_mfma_f32_16x16x32_bf16 v[108:111], a[232:235], v[172:175], v[108:111]
    s_waitcnt vmcnt(16)
    v_mfma_f32_16x16x32_bf16 v[96:99], a[236:239], v[176:179], v[96:99]
    buffer_load_dwordx4 a[232:235], v32, s[24:27], s43 offen offset:0
    v_mfma_f32_16x16x32_bf16 v[100:103], a[236:239], v[180:183], v[100:103]
    v_mfma_f32_16x16x32_bf16 v[104:107], a[236:239], v[184:187], v[104:107]
    v_mfma_f32_16x16x32_bf16 v[108:111], a[236:239], v[188:191], v[108:111]
    s_waitcnt vmcnt(16)
    v_mfma_f32_16x16x32_bf16 v[96:99], a[240:243], v[192:195], v[96:99]
    buffer_load_dwordx4 a[236:239], v32, s[24:27], s43 offen offset:1024
    v_mfma_f32_16x16x32_bf16 v[100:103], a[240:243], v[196:199], v[100:103]
    v_mfma_f32_16x16x32_bf16 v[104:107], a[240:243], v[200:203], v[104:107]
    v_mfma_f32_16x16x32_bf16 v[108:111], a[240:243], v[204:207], v[108:111]
    s_waitcnt vmcnt(16)
    v_mfma_f32_16x16x32_bf16 v[96:99], a[244:247], v[208:211], v[96:99]
    buffer_load_dwordx4 a[240:243], v32, s[24:27], s43 offen offset:2048
    v_mfma_f32_16x16x32_bf16 v[100:103], a[244:247], v[212:215], v[100:103]
    v_mfma_f32_16x16x32_bf16 v[104:107], a[244:247], v[216:219], v[104:107]
    v_mfma_f32_16x16x32_bf16 v[108:111], a[244:247], v[220:223], v[108:111]
    s_waitcnt vmcnt(16)
    v_mfma_f32_16x16x32_bf16 v[96:99], a[248:251], v[224:227], v[96:99]
    buffer_load_dwordx4 a[244:247], v32, s[24:27], s43 offen offset:3072
    s_add_u32 s43, s43, 4096
    v_mfma_f32_16x16x32_bf16 v[100:103], a[248:251], v[228:231], v[100:103]
    v_mfma_f32_16x16x32_bf16 v[104:107], a[248:251], v[232:235], v[104:107]
    v_mfma_f32_16x16x32_bf16 v[108:111], a[248:251], v[236:239], v[108:111]
    s_waitcnt vmcnt(16)
    v_mfma_f32_16x16x32_bf16 v[96:99], a[252:255], v[240:243], v[96:99]
    buffer_load_dwordx4 a[248:251], v32, s[24:27], s43 offen offset:0
    v_mfma_f32_16x16x32_bf16 v[100:103], a[252:255], v[244:247], v[100:103]
    s_cmp_eq_u32 s62, 2
    s_cbranch_scc0 L_ffn_nopoll
    v_lshlrev_b32 v5, 2, v2
    s_lshl_b32 s59, s34, 7
    s_add_u32 s59, s59, s67
    s_add_u32 s56, s67, 1024
    s_mov_b64 exec, 0xff
    buffer_load_dword v6, v5, s[24:27], s59 offen sc1
    buffer_load_dword v7, v5, s[24:27], s56 offen sc1
    s_mov_b64 exec, -1
L_ffn_nopoll:
    v_mfma_f32_16x16x32_bf16 v[104:107], a[252:255], v[248:251], v[104:107]
    v_mfma_f32_16x16x32_bf16 v[108:111], a[252:255], v[252:255], v[108:111]
    s_add_u32 s62, s62, 1
    s_cmp_lt_u32 s62, 3
    s_cbranch_scc1 L_ffn_p2
    s_waitcnt vmcnt(16)
    v_mfma_f32_16x16x32_bf16 v[80:83], a[184:187], a[0:3], 0
    buffer_load_dwordx4 a[252:255], v32, s[24:27], s43 offen offset:1024
    s_mov_b32 s43, s55
    v_mfma_f32_16x16x32_bf16 v[84:87], a[184:187], a[4:7], 0
    s_mov_b32 s51, 0
    s_add_u32 s57, s65, 84992
    v_add_u32 v46, s57, v32
    v_add_u32 v47, 49152, v46
    v_mfma_f32_16x16x32_bf16 v[88:91], a[184:187], a[8:11], 0
    v_mfma_f32_16x16x32_bf16 v[92:95], a[184:187], a[12:15], 0
    s_waitcnt vmcnt(16)
    v_mfma_f32_16x16x32_bf16 v[80:83], a[188:191], a[16:19], v[80:83]
    v_mfma_f32_16x16x32_bf16 v[84:87], a[188:191], a[20:23], v[84:87]
    v_cvt_pk_bf16_f32 v64, v96, v97
    v_cvt_pk_bf16_f32 v65, v98, v99
    v_mfma_f32_16x16x32_bf16 v[88:91], a[188:191], a[24:27], v[88:91]
    v_cvt_pk_bf16_f32 v66, v100, v101
    v_cvt_pk_bf16_f32 v67, v102, v103
    v_mfma_f32_16x16x32_bf16 v[92:95], a[188:191], a[28:31], v[92:95]
    s_waitcnt vmcnt(15)
    v_mfma_f32_16x16x32_bf16 v[80:83], a[192:195], a[32:35], v[80:83]
    v_mfma_f32_16x16x32_bf16 v[84:87], a[192:195], a[36:39], v[84:87]
    v_cvt_pk_bf16_f32 v68, v104, v105
    v_cvt_pk_bf16_f32 v69, v106, v107
    v_mfma_f32_16x16x32_bf16 v[88:91], a[192:195], a[40:43], v[88:91]
    v_cvt_pk_bf16_f32 v70, v108, v109
    v_cvt_pk_bf16_f32 v71, v110, v111
    v_mfma_f32_16x16x32_bf16 v[92:95], a[192:195], a[44:47], v[92:95]
    s_waitcnt vmcnt(14)
    v_mfma_f32_16x16x32_bf16 v[80:83], a[196:199], a[48:51], v[80:83]
    v_mfma_f32_16x16x32_bf16 v[84:87], a[196:199], a[52:55], v[84:87]
    s_lshl_b32 s72, s71, 6
    s_add_u32 s72, s72, s60
    buffer_store_dwordx4 v[64:67], v32, s[24:27], s72 offen sc1
    buffer_store_dwordx4 v[68:71], v32, s[24:27], s72 offen offset:1024 sc1
    s_mov_b32 s63, s71
    s_add_u32 s69, s69, 128
    s_and_b32 s69, s69, 1023
    s_mov_b32 s71, s69
    v_mfma_f32_16x16x32_bf16 v[88:91], a[196:199], a[56:59], v[88:91]
    v_mfma_f32_16x16x32_bf16 v[92:95], a[196:199], a[60:63], v[92:95]
    s_waitcnt vmcnt(15)
    v_mfma_f32_16x16x32_bf16 v[80:83], a[200:203], a[64:67], v[80:83]
    v_mfma_f32_16x16x32_bf16 v[84:87], a[200:203], a[68:71], v[84:87]
    s_add_u32 s57, s34, 3
    s_and_b32 s57, s57, 7
    s_mul_i32 s46, s57, 2359296
    s_add_u32 s46, s46, s73
    s_add_u32 s46, s46, 7471104
    buffer_load_dwordx4 v[128:131], v32, s[24:27], s46 offen sc1
    buffer_load_dwordx4 v[132:135], v32, s[24:27], s46 offen offset:1024 sc1
    v_mfma_f32_16x16x32_bf16 v[88:91], a[200:203], a[72:75], v[88:91]
    v_mfma_f32_16x16x32_bf16 v[92:95], a[200:203], a[76:79], v[92:95]
    s_waitcnt vmcnt(16)
    v_mfma_f32_16x16x32_bf16 v[80:83], a[204:207], a[80:83], v[80:83]
    v_mfma_f32_16x16x32_bf16 v[84:87], a[204:207], a[84:87], v[84:87]
    v_mfma_f32_16x16x32_bf16 v[88:91], a[204:207], a[88:91], v[88:91]
    v_mfma_f32_16x16x32_bf16 v[92:95], a[204:207], a[92:95], v[92:95]
    s_waitcnt vmcnt(15)
    v_mfma_f32_16x16x32_bf16 v[80:83], a[208:211], a[96:99], v[80:83]
    v_mfma_f32_16x16x32_bf16 v[84:87], a[208:211], a[100:103], v[84:87]
    s_mov_b32 s50, 0
    s_add_u32 s57, s34, 7
    s_and_b32 s57, s57, 7
    s_bitset1_b32 s50, s57
    s_add_u32 s57, s34, 6
    s_and_b32 s57, s57, 7
    s_bitset1_b32 s50, s57
    s_add_u32 s57, s34, 5
    s_and_b32 s57, s57, 7
    s_bitset1_b32 s50, s57
    s_add_u32 s57, s34, 4
    s_and_b32 s57, s57, 7
    s_bitset1_b32 s50, s57
    s_mov_b32 s61, 0x20000
    s_waitcnt vmcnt(4)
L_ffn_pa:
    s_mov_b64 exec, 0xff
    v_cmp_ne_u32 vcc, 1, v6
    v_cmp_ne_u32 s[48:49], 1, v7
    s_mov_b64 exec, -1
    s_sub_u32 s61, s61, 1
    s_nop 0
    s_and_b64 vcc, vcc, s[50:51]
    s_or_b64 vcc, vcc, s[48:49]
    s_cmp_eq_u64 vcc, 0
    s_cbranch_scc1 L_ffn_pa_x
    s_cmp_eq_u32 s61, 0
    s_cbranch_scc1 L_ffn_pa_x
    s_branch L_ffn_pa_r
L_ffn_pa_x:
    v_mfma_f32_16x16x32_bf16 v[88:91], a[208:211], a[104:107], v[88:91]
    s_add_u32 s57, s34, 7
    s_and_b32 s57, s57, 7
    s_mul_i32 s46, s57, 2359296
    s_add_u32 s46, s46, s73
    s_add_u32 s46, s46, 7471104
    buffer_load_dwordx4 v[112:115], v32, s[24:27], s46 offen sc1
    buffer_load_dwordx4 v[116:119], v32, s[24:27], s46 offen offset:1024 sc1
    v_mfma_f32_16x16x32_bf16 v[92:95], a[208:211], a[108:111], v[92:95]
    v_mfma_f32_16x16x32_bf16 v[80:83], a[212:215], a[112:115], v[80:83]
    v_mfma_f32_16x16x32_bf16 v[84:87], a[212:215], a[116:119], v[84:87]
    s_add_u32 s57, s34, 6
    s_and_b32 s57, s57, 7
    s_mul_i32 s46, s57, 2359296
    s_add_u32 s46, s46, s73
    s_add_u32 s46, s46, 7471104
    buffer_load_dwordx4 v[120:123], v32, s[24:27], s46 offen sc1
    buffer_load_dwordx4 v[124:127], v32, s[24:27], s46 offen offset:1024 sc1
    v_mfma_f32_16x16x32_bf16 v[88:91], a[212:215], a[120:123], v[88:91]
    v_mfma_f32_16x16x32_bf16 v[92:95], a[212:215], a[124:127], v[92:95]
    v_mfma_f32_16x16x32_bf16 v[80:83], a[216:219], a[128:131], v[80:83]
    v_mfma_f32_16x16x32_bf16 v[84:87], a[216:219], a[132:135], v[84:87]
    s_add_u32 s57, s34, 5
    s_and_b32 s57, s57, 7
    s_mul_i32 s46, s57, 2359296
    s_add_u32 s46, s46, s73
    s_add_u32 s46, s46, 7471104
    buffer_load_dwordx4 a[200:203], v32, s[24:27], s46 offen sc1
    buffer_load_dwordx4 a[204:207], v32, s[24:27], s46 offen offset:1024 sc1
    v_mfma_f32_16x16x32_bf16 v[88:91], a[216:219], a[136:139], v[88:91]
    v_mfma_f32_16x16x32_bf16 v[92:95], a[216:219], a[140:143], v[92:95]
    v_mfma_f32_16x16x32_bf16 v[80:83], a[220:223], a[144:147], v[80:83]
    v_mfma_f32_16x16x32_bf16 v[84:87], a[220:223], a[148:151], v[84:87]
    s_add_u32 s57, s34, 4
    s_and_b32 s57, s57, 7
    s_mul_i32 s46, s57, 2359296
    s_add_u32 s46, s46, s73
    s_add_u32 s46, s46, 7471104
    buffer_load_dwordx4 a[208:211], v32, s[24:27], s46 offen sc1
    buffer_load_dwordx4 a[212:215], v32, s[24:27], s46 offen offset:1024 sc1
    v_lshlrev_b32 v48, 16, v18
    v_mfma_f32_16x16x32_bf16 v[88:91], a[220:223], a[152:155], v[88:91]
    v_and_b32 v49, s58, v18
    v_lshlrev_b32 v50, 16, v19
    v_mfma_f32_16x16x32_bf16 v[92:95], a[220:223], a[156:159], v[92:95]
    v_mfma_f32_16x16x32_bf16 v[80:83], a[224:227], a[160:163], v[80:83]
    v_mfma_f32_16x16x32_bf16 v[84:87], a[224:227], a[164:167], v[84:87]
    v_and_b32 v51, s58, v19
    v_mfma_f32_16x16x32_bf16 v[88:91], a[224:227], a[168:171], v[88:91]
    v_lshlrev_b32 v56, 16, v40
    v_mfma_f32_16x16x32_bf16 v[92:95], a[224:227], a[172:175], v[92:95]
    v_and_b32 v57, s58, v40
    v_mfma_f32_16x16x32_bf16 v[80:83], a[228:231], a[176:179], v[80:83]
    v_mfma_f32_16x16x32_bf16 v[84:87], a[228:231], a[180:183], v[84:87]
    v_add_f32 v56, v56, v48
    v_mfma_f32_16x16x32_bf16 v[88:91], a[228:231], v[152:155], v[88:91]
    v_add_f32 v57, v57, v49
    v_mfma_f32_16x16x32_bf16 v[92:95], a[228:231], v[156:159], v[92:95]
    v_lshlrev_b32 v58, 16, v41
    v_mfma_f32_16x16x32_bf16 v[80:83], a[232:235], v[160:163], v[80:83]
    v_mfma_f32_16x16x32_bf16 v[84:87], a[232:235], v[164:167], v[84:87]
    v_and_b32 v59, s58, v41
    v_mfma_f32_16x16x32_bf16 v[88:91], a[232:235], v[168:171], v[88:91]
    v_add_f32 v58, v58, v50
    v_mfma_f32_16x16x32_bf16 v[92:95], a[232:235], v[172:175], v[92:95]
    v_add_f32 v59, v59, v51
    v_mfma_f32_16x16x32_bf16 v[80:83], a[236:239], v[176:179], v[80:83]
    v_mfma_f32_16x16x32_bf16 v[84:87], a[236:239], v[180:183], v[84:87]
    s_cmp_eq_u32 s38, s79
    s_cbranch_scc0 L_ffn_nx1
    s_add_u32 s72, s75, 7471104
    buffer_load_dwordx4 a[216:219], v32, s[24:27], s72 offen sc1
    s_add_u32 s72, s75, 9830400
    buffer_load_dwordx4 a[220:223], v32, s[24:27], s72 offen sc1
    s_add_u32 s72, s75, 12189696
    buffer_load_dwordx4 a[224:227], v32, s[24:27], s72 offen sc1
    s_add_u32 s72, s75, 14548992
    buffer_load_dwordx4 a[228:231], v32, s[24:27], s72 offen sc1
L_ffn_nx1:
    v_lshlrev_b32 v60, 16, v42
    v_mfma_f32_16x16x32_bf16 v[88:91], a[236:239], v[184:187], v[88:91]
    v_and_b32 v61, s58, v42
    v_add_f32 v60, v60, v48
    v_mfma_f32_16x16x32_bf16 v[92:95], a[236:239], v[188:191], v[92:95]
    v_mfma_f32_16x16x32_bf16 v[80:83], a[240:243], v[192:195], v[80:83]
    v_mfma_f32_16x16x32_bf16 v[84:87], a[240:243], v[196:199], v[84:87]
    v_add_f32 v61, v61, v49
    v_mfma_f32_16x16x32_bf16 v[88:91], a[240:243], v[200:203], v[88:91]
    v_lshlrev_b32 v62, 16, v43
    v_mfma_f32_16x16x32_bf16 v[92:95], a[240:243], v[204:207], v[92:95]
    v_and_b32 v63, s58, v43
    v_mfma_f32_16x16x32_bf16 v[80:83], a[244:247], v[208:211], v[80:83]
    ds_read_b128 a[184:187], v46 offset:0
    v_mfma_f32_16x16x32_bf16 v[84:87], a[244:247], v[212:215], v[84:87]
    v_add_f32 v62, v62, v50
    v_mfma_f32_16x16x32_bf16 v[88:91], a[244:247], v[216:219], v[88:91]
    v_add_f32 v63, v63, v51
    v_mfma_f32_16x16x32_bf16 v[92:95], a[244:247], v[220:223], v[92:95]
    v_mfma_f32_16x16x32_bf16 v[80:83], a[248:251], v[224:227], v[80:83]
    ds_read_b128 a[188:191], v46 offset:4096
    v_mfma_f32_16x16x32_bf16 v[84:87], a[248:251], v[228:231], v[84:87]
    v_mfma_f32_16x16x32_bf16 v[88:91], a[248:251], v[232:235], v[88:91]
    v_mfma_f32_16x16x32_bf16 v[92:95], a[248:251], v[236:239], v[92:95]
    v_mfma_f32_16x16x32_bf16 v[80:83], a[252:255], v[240:243], v[80:83]
    ds_read_b128 a[192:195], v46 offset:8192
    v_mfma_f32_16x16x32_bf16 v[84:87], a[252:255], v[244:247], v[84:87]
    s_cmp_eq_u32 s38, s79
    s_cbranch_scc0 L_ffn_nx2
    s_add_u32 s72, s75, 16908288
    buffer_load_dwordx4 a[232:235], v32, s[24:27], s72 offen sc1
    s_add_u32 s72, s75, 19267584
    buffer_load_dwordx4 a[236:239], v32, s[24:27], s72 offen sc1
    s_add_u32 s72, s75, 21626880
    buffer_load_dwordx4 a[240:243], v32, s[24:27], s72 offen sc1
    s_add_u32 s72, s75, 23986176
    buffer_load_dwordx4 a[244:247], v32, s[24:27], s72 offen sc1
L_ffn_nx2:
    v_mfma_f32_16x16x32_bf16 v[88:91], a[252:255], v[248:251], v[88:91]
    v_mfma_f32_16x16x32_bf16 v[92:95], a[252:255], v[252:255], v[92:95]
    s_waitcnt lgkmcnt(2)
    v_mfma_f32_16x16x32_bf16 v[96:99], a[184:187], a[0:3], 0
    ds_read_b128 a[196:199], v46 offset:12288
    v_mfma_f32_16x16x32_bf16 v[100:103], a[184:187], a[4:7], 0
    v_mfma_f32_16x16x32_bf16 v[104:107], a[184:187], a[8:11], 0
    v_mfma_f32_16x16x32_bf16 v[108:111], a[184:187], a[12:15], 0
    s_waitcnt lgkmcnt(2)
    v_mfma_f32_16x16x32_bf16 v[96:99], a[188:191], a[16:19], v[96:99]
    ds_read_b128 a[184:187], v46 offset:16384
    v_mfma_f32_16x16x32_bf16 v[100:103], a[188:191], a[20:23], v[100:103]
    v_cvt_pk_bf16_f32 v64, v80, v81
    v_cvt_pk_bf16_f32 v65, v82, v83
    v_mfma_f32_16x16x32_bf16 v[104:107], a[188:191], a[24:27], v[104:107]
    v_cvt_pk_bf16_f32 v66, v84, v85
    v_cvt_pk_bf16_f32 v67, v86, v87
    v_mfma_f32_16x16x32_bf16 v[108:111], a[188:191], a[28:31], v[108:111]
    s_waitcnt lgkmcnt(2)
    v_mfma_f32_16x16x32_bf16 v[96:99], a[192:195], a[32:35], v[96:99]
    ds_read_b128 a[188:191], v46 offset:20480
    v_mfma_f32_16x16x32_bf16 v[100:103], a[192:195], a[36:39], v[100:103]
    v_cvt_pk_bf16_f32 v68, v88, v89
    v_cvt_pk_bf16_f32 v69, v90, v91
    v_mfma_f32_16x16x32_bf16 v[104:107], a[192:195], a[40:43], v[104:107]
    v_cvt_pk_bf16_f32 v70, v92, v93
    v_cvt_pk_bf16_f32 v71, v94, v95
    v_mfma_f32_16x16x32_bf16 v[108:111], a[192:195], a[44:47], v[108:111]
    s_waitcnt lgkmcnt(2)
    v_mfma_f32_16x16x32_bf16 v[96:99], a[196:199], a[48:51], v[96:99]
    ds_read_b128 a[192:195], v46 offset:24576
    v_mfma_f32_16x16x32_bf16 v[100:103], a[196:199], a[52:55], v[100:103]
    s_lshl_b32 s72, s71, 6
    s_add_u32 s72, s72, s60
    buffer_store_dwordx4 v[64:67], v32, s[24:27], s72 offen sc1
    buffer_store_dwordx4 v[68:71], v32, s[24:27], s72 offen offset:1024 sc1
    s_mov_b32 s63, s71
    s_add_u32 s69, s69, 128
    s_and_b32 s69, s69, 1023
    s_mov_b32 s71, s69
    v_mfma_f32_16x16x32_bf16 v[104:107], a[196:199], a[56:59], v[104:107]
    v_mfma_f32_16x16x32_bf16 v[108:111], a[196:199], a[60:63], v[108:111]
    s_waitcnt lgkmcnt(2)
    v_mfma_f32_16x16x32_bf16 v[96:99], a[184:187], a[64:67], v[96:99]
    ds_read_b128 a[196:199], v46 offset:28672
    v_mfma_f32_16x16x32_bf16 v[100:103], a[184:187], a[68:71], v[100:103]
    s_add_u32 s57, s34, 2
    s_and_b32 s57, s57, 7
    s_mul_i32 s46, s57, 2359296
    s_add_u32 s46, s46, s73
    s_add_u32 s46, s46, 7471104
    buffer_load_dwordx4 v[136:139], v32, s[24:27], s46 offen sc1
    buffer_load_dwordx4 v[140:143], v32, s[24:27], s46 offen offset:1024 sc1
    v_mfma_f32_16x16x32_bf16 v[104:107], a[184:187], a[72:75], v[104:107]
    v_mfma_f32_16x16x32_bf16 v[108:111], a[184:187], a[76:79], v[108:111]
    s_waitcnt lgkmcnt(2)
    v_mfma_f32_16x16x32_bf16 v[96:99], a[188:191], a[80:83], v[96:99]
    ds_read_b128 a[184:187], v46 offset:32768
    v_mfma_f32_16x16x32_bf16 v[100:103], a[188:191], a[84:87], v[100:103]
    v_lshlrev_b32 v48, 16, v16
    v_and_b32 v49, s58, v16
    v_mfma_f32_16x16x32_bf16 v[104:107], a[188:191], a[88:91], v[104:107]
    v_lshlrev_b32 v50, 16, v17
    v_and_b32 v51, s58, v17
    v_mfma_f32_16x16x32_bf16 v[108:111], a[188:191], a[92:95], v[108:111]
    s_waitcnt lgkmcnt(2)
    v_mfma_f32_16x16x32_bf16 v[96:99], a[192:195], a[96:99], v[96:99]
    ds_read_b128 a[188:191], v46 offset:36864
    s_waitcnt vmcnt(10)
    v_mfma_f32_16x16x32_bf16 v[100:103], a[192:195], a[100:103], v[100:103]
    v_mfma_f32_16x16x32_bf16 v[96:99], v[10:13], v[112:115], v[96:99]
    v_mfma_f32_16x16x32_bf16 v[100:103], v[8:11], v[112:115], v[100:103]
    v_mfma_f32_16x16x32_bf16 v[104:107], v[10:13], v[116:119], v[104:107]
    v_mfma_f32_16x16x32_bf16 v[108:111], v[8:11], v[116:119], v[108:111]
    v_lshlrev_b32 v80, 16, v24
    v_mfma_f32_16x16x32_bf16 v[104:107], a[192:195], a[104:107], v[104:107]
    v_and_b32 v81, s58, v24
    v_add_f32 v80, v80, v48
    v_add_f32 v81, v81, v49
    v_mfma_f32_16x16x32_bf16 v[108:111], a[192:195], a[108:111], v[108:111]
    s_waitcnt lgkmcnt(2)
    v_mfma_f32_16x16x32_bf16 v[96:99], a[196:199], a[112:115], v[96:99]
    ds_read_b128 a[192:195], v46 offset:40960
    v_mfma_f32_16x16x32_bf16 v[100:103], a[196:199], a[116:119], v[100:103]
    v_lshlrev_b32 v82, 16, v25
    v_and_b32 v83, s58, v25
    v_mfma_f32_16x16x32_bf16 v[104:107], a[196:199], a[120:123], v[104:107]
    v_add_f32 v82, v82, v50
    v_add_f32 v83, v83, v51
    v_mfma_f32_16x16x32_bf16 v[108:111], a[196:199], a[124:127], v[108:111]
    s_waitcnt lgkmcnt(2)
    v_mfma_f32_16x16x32_bf16 v[96:99], a[184:187], a[128:131], v[96:99]
    ds_read_b128 a[196:199], v46 offset:45056
    s_waitcnt vmcnt(8)
    v_mfma_f32_16x16x32_bf16 v[100:103], a[184:187], a[132:135], v[100:103]
    v_mfma_f32_16x16x32_bf16 v[96:99], v[10:13], v[120:123], v[96:99]
    v_mfma_f32_16x16x32_bf16 v[100:103], v[8:11], v[120:123], v[100:103]
    v_mfma_f32_16x16x32_bf16 v[104:107], v[10:13], v[124:127], v[104:107]
    v_mfma_f32_16x16x32_bf16 v[108:111], v[8:11], v[124:127], v[108:111]
    v_lshlrev_b32 v84, 16, v26
    v_mfma_f32_16x16x32_bf16 v[104:107], a[184:187], a[136:139], v[104:107]
    v_and_b32 v85, s58, v26
    v_add_f32 v84, v84, v48
    v_add_f32 v85, v85, v49
    v_mfma_f32_16x16x32_bf16 v[108:111], a[184:187], a[140:143], v[108:111]
    s_waitcnt lgkmcnt(2)
    v_mfma_f32_16x16x32_bf16 v[96:99], a[188:191], a[144:147], v[96:99]
    ds_read_b128 a[184:187], v47 offset:0
    v_mfma_f32_16x16x32_bf16 v[100:103], a[188:191], a[148:151], v[100:103]
    v_lshlrev_b32 v86, 16, v27
    v_and_b32 v87, s58, v27
    v_mfma_f32_16x16x32_bf16 v[104:107], a[188:191], a[152:155], v[104:107]
    v_add_f32 v86, v86, v50
    v_add_f32 v87, v87, v51
    v_mfma_f32_16x16x32_bf16 v[108:111], a[188:191], a[156:159], v[108:111]
    s_waitcnt lgkmcnt(2)
    v_mfma_f32_16x16x32_bf16 v[96:99], a[192:195], a[160:163], v[96:99]
    ds_read_b128 a[188:191], v47 offset:4096
    s_waitcnt vmcnt(6)
    v_mfma_f32_16x16x32_bf16 v[100:103], a[192:195], a[164:167], v[100:103]
    v_mfma_f32_16x16x32_bf16 v[96:99], v[10:13], a[200:203], v[96:99]
    v_mfma_f32_16x16x32_bf16 v[100:103], v[8:11], a[200:203], v[100:103]
    v_mfma_f32_16x16x32_bf16 v[104:107], v[10:13], a[204:207], v[104:107]
    v_mfma_f32_16x16x32_bf16 v[108:111], v[8:11], a[204:207], v[108:111]
    v_lshlrev_b32 v88, 16, v28
    v_mfma_f32_16x16x32_bf16 v[104:107], a[192:195], a[168:171], v[104:107]
    v_and_b32 v89, s58, v28
    v_add_f32 v88, v88, v48
    v_add_f32 v89, v89, v49
    v_mfma_f32_16x16x32_bf16 v[108:111], a[192:195], a[172:175], v[108:111]
    s_waitcnt lgkmcnt(2)
    v_mfma_f32_16x16x32_bf16 v[96:99], a[196:199], a[176:179], v[96:99]
    ds_read_b128 a[192:195], v47 offset:8192
    v_mfma_f32_16x16x32_bf16 v[100:103], a[196:199], a[180:183], v[100:103]
    v_lshlrev_b32 v90, 16, v29
    v_and_b32 v91, s58, v29
    v_mfma_f32_16x16x32_bf16 v[104:107], a[196:199], v[152:155], v[104:107]
    v_add_f32 v90, v90, v50
    v_add_f32 v91, v91, v51
    v_mfma_f32_16x16x32_bf16 v[108:111], a[196:199], v[156:159], v[108:111]
    s_waitcnt lgkmcnt(2)
    v_mfma_f32_16x16x32_bf16 v[96:99], a[184:187], v[160:163], v[96:99]
    ds_read_b128 a[196:199], v47 offset:12288
    s_waitcnt vmcnt(4)
    v_mfma_f32_16x16x32_bf16 v[100:103], a[184:187], v[164:167], v[100:103]
    v_mfma_f32_16x16x32_bf16 v[96:99], v[10:13], a[208:211], v[96:99]
    v_mfma_f32_16x16x32_bf16 v[100:103], v[8:11], a[208:211], v[100:103]
    v_mfma_f32_16x16x32_bf16 v[104:107], v[10:13], a[212:215], v[104:107]
    v_mfma_f32_16x16x32_bf16 v[108:111], v[8:11], a[212:215], v[108:111]
    v_lshlrev_b32 v92, 16, v30
    v_mfma_f32_16x16x32_bf16 v[104:107], a[184:187], v[168:171], v[104:107]
    v_and_b32 v93, s58, v30
    v_add_f32 v92, v92, v48
    v_add_f32 v93, v93, v49
    v_mfma_f32_16x16x32_bf16 v[108:111], a[184:187], v[172:175], v[108:111]
    s_waitcnt lgkmcnt(2)
    v_mfma_f32_16x16x32_bf16 v[96:99], a[188:191], v[176:179], v[96:99]
    ds_read_b128 a[184:187], v47 offset:16384
    v_mfma_f32_16x16x32_bf16 v[100:103], a[188:191], v[180:183], v[100:103]
    v_lshlrev_b32 v94, 16, v31
    v_and_b32 v95, s58, v31
    v_mfma_f32_16x16x32_bf16 v[104:107], a[188:191], v[184:187], v[104:107]
    v_add_f32 v94, v94, v50
    v_add_f32 v95, v95, v51
    v_mfma_f32_16x16x32_bf16 v[108:111], a[188:191], v[188:191], v[108:111]
    s_waitcnt lgkmcnt(2)
    v_mfma_f32_16x16x32_bf16 v[96:99], a[192:195], v[192:195], v[96:99]
    ds_read_b128 a[188:191], v47 offset:20480
    v_mfma_f32_16x16x32_bf16 v[100:103], a[192:195], v[196:199], v[100:103]
    v_mfma_f32_16x16x32_bf16 v[104:107], a[192:195], v[200:203], v[104:107]
    v_mfma_f32_16x16x32_bf16 v[108:111], a[192:195], v[204:207], v[108:111]
    s_waitcnt lgkmcnt(2)
    v_mfma_f32_16x16x32_bf16 v[96:99], a[196:199], v[208:211], v[96:99]
    v_mfma_f32_16x16x32_bf16 v[100:103], a[196:199], v[212:215], v[100:103]
    v_mfma_f32_16x16x32_bf16 v[104:107], a[196:199], v[216:219], v[104:107]
    v_mfma_f32_16x16x32_bf16 v[108:111], a[196:199], v[220:223], v[108:111]
    s_waitcnt lgkmcnt(1)
    v_mfma_f32_16x16x32_bf16 v[96:99], a[184:187], v[224:227], v[96:99]
    v_mfma_f32_16x16x32_bf16 v[100:103], a[184:187], v[228:231], v[100:103]
    s_add_u32 s57, s34, 1
    s_and_b32 s57, s57, 7
    s_mul_i32 s46, s57, 2359296
    s_add_u32 s46, s46, s73
    s_add_u32 s46, s46, 7471104
    buffer_load_dwordx4 v[144:147], v32, s[24:27], s46 offen sc1
    buffer_load_dwordx4 v[148:151], v32, s[24:27], s46 offen offset:1024 sc1
    v_mfma_f32_16x16x32_bf16 v[104:107], a[184:187], v[232:235], v[104:107]
    v_mfma_f32_16x16x32_bf16 v[108:111], a[184:187], v[236:239], v[108:111]
    s_waitcnt lgkmcnt(0)
    v_mfma_f32_16x16x32_bf16 v[96:99], a[188:191], v[240:243], v[96:99]
    v_mfma_f32_16x16x32_bf16 v[100:103], a[188:191], v[244:247], v[100:103]
    v_mfma_f32_16x16x32_bf16 v[104:107], a[188:191], v[248:251], v[104:107]
    v_mfma_f32_16x16x32_bf16 v[108:111], a[188:191], v[252:255], v[108:111]
    s_mov_b32 s61, 0x20000
    s_waitcnt vmcnt(2)
L_ffn_s5:
    v_max3_u32 v44, v128, v129, v130
    v_max3_u32 v45, v131, v132, v133
    v_max3_u32 v44, v44, v134, v135
    v_max_u32 v44, v44, v45
    v_cmp_eq_u32 vcc, -1, v44
    s_sub_u32 s61, s61, 1
    s_nop 0
    s_cmp_eq_u64 vcc, 0
    s_cbranch_scc1 L_ffn_s5_x
    s_cmp_eq_u32 s61, 0
    s_cbranch_scc1 L_ffn_s5_x
    s_add_u32 s57, s34, 3
    s_and_b32 s57, s57, 7
    s_mul_i32 s46, s57, 2359296
    s_add_u32 s46, s46, s73
    s_add_u32 s46, s46, 7471104
    buffer_load_dwordx4 v[128:131], v32, s[24:27], s46 offen sc1
    buffer_load_dwordx4 v[132:135], v32, s[24:27], s46 offen offset:1024 sc1
    s_waitcnt vmcnt(0)
    s_branch L_ffn_s5
L_ffn_s5_x:
    v_mfma_f32_16x16x32_bf16 v[96:99], v[10:13], v[128:131], v[96:99]
    v_mfma_f32_16x16x32_bf16 v[100:103], v[8:11], v[128:131], v[100:103]
    v_mfma_f32_16x16x32_bf16 v[104:107], v[10:13], v[132:135], v[104:107]
    v_mfma_f32_16x16x32_bf16 v[108:111], v[8:11], v[132:135], v[108:111]
    s_cmp_eq_u32 s38, s79
    s_cbranch_scc0 L_ffn_nx3
    v_mfma_f32_16x16x32_bf16 v[72:75], v[10:13], a[216:219], 0
    v_mfma_f32_16x16x32_bf16 v[76:79], v[8:11], a[216:219], 0
    v_mfma_f32_16x16x32_bf16 v[72:75], v[10:13], a[220:223], v[72:75]
    v_mfma_f32_16x16x32_bf16 v[76:79], v[8:11], a[220:223], v[76:79]
    v_mfma_f32_16x16x32_bf16 v[72:75], v[10:13], a[224:227], v[72:75]
    v_mfma_f32_16x16x32_bf16 v[76:79], v[8:11], a[224:227], v[76:79]
    v_mfma_f32_16x16x32_bf16 v[72:75], v[10:13], a[228:231], v[72:75]
    v_mfma_f32_16x16x32_bf16 v[76:79], v[8:11], a[228:231], v[76:79]
    v_mfma_f32_16x16x32_bf16 v[72:75], v[10:13], a[232:235], v[72:75]
    v_mfma_f32_16x16x32_bf16 v[76:79], v[8:11], a[232:235], v[76:79]
    v_mfma_f32_16x16x32_bf16 v[72:75], v[10:13], a[236:239], v[72:75]
    v_mfma_f32_16x16x32_bf16 v[76:79], v[8:11], a[236:239], v[76:79]
    v_mfma_f32_16x16x32_bf16 v[72:75], v[10:13], a[240:243], v[72:75]
    v_mfma_f32_16x16x32_bf16 v[76:79], v[8:11], a[240:243], v[76:79]
    v_mfma_f32_16x16x32_bf16 v[72:75], v[10:13], a[244:247], v[72:75]
    v_mfma_f32_16x16x32_bf16 v[76:79], v[8:11], a[244:247], v[76:79]
L_ffn_nx3:
    s_mov_b32 s61, 0x20000
    s_waitcnt vmcnt(2)
L_ffn_s6:
    v_max3_u32 v44, v136, v137, v138
    v_max3_u32 v45, v139, v140, v141
    v_max3_u32 v44, v44, v142, v143
    v_max_u32 v44, v44, v45
    v_cmp_eq_u32 vcc, -1, v44
    s_sub_u32 s61, s61, 1
    s_nop 0
    s_cmp_eq_u64 vcc, 0
    s_cbranch_scc1 L_ffn_s6_x
    s_cmp_eq_u32 s61, 0
    s_cbranch_scc1 L_ffn_s6_x
    s_add_u32 s57, s34, 2
    s_and_b32 s57, s57, 7
    s_mul_i32 s46, s57, 2359296
    s_add_u32 s46, s46, s73
    s_add_u32 s46, s46, 7471104
    buffer_load_dwordx4 v[136:139], v32, s[24:27], s46 offen sc1
    buffer_load_dwordx4 v[140:143], v32, s[24:27], s46 offen offset:1024 sc1
    s_waitcnt vmcnt(0)
    s_branch L_ffn_s6
L_ffn_s6_x:
    v_mfma_f32_16x16x32_bf16 v[96:99], v[10:13], v[136:139], v[96:99]
    v_mfma_f32_16x16x32_bf16 v[100:103], v[8:11], v[136:139], v[100:103]
    v_mfma_f32_16x16x32_bf16 v[104:107], v[10:13], v[140:143], v[104:107]
    v_mfma_f32_16x16x32_bf16 v[108:111], v[8:11], v[140:143], v[108:111]
    s_cmp_eq_u32 s38, s79
    s_cbranch_scc0 L_ffn_nxo
    s_cmp_eq_u32 s74, 1
    s_cselect_b64 s[48:49], -1, 0
    s_nop 0
    v_cndmask_b32 v46, v34, v36, s[48:49]
    v_cndmask_b32 v47, v35, v37, s[48:49]
    v_fmac_f32 v56, v46, v72
    v_fmac_f32 v57, v46, v73
    v_fmac_f32 v58, v46, v74
    v_fmac_f32 v59, v46, v75
    v_fmac_f32 v60, v47, v76
    v_fmac_f32 v61, v47, v77
    v_fmac_f32 v62, v47, v78
    v_fmac_f32 v63, v47, v79
    v_cvt_pk_bf16_f32 v52, v56, v57
    v_cvt_pk_bf16_f32 v53, v58, v59
    v_cvt_pk_bf16_f32 v54, v60, v61
    v_cvt_pk_bf16_f32 v55, v62, v63
    s_nop 1
    v_permlane16_swap_b32 v52, v54
    v_permlane16_swap_b32 v53, v55
    buffer_store_dwordx4 v[52:55], v23, s[20:23], s78 offen sc1
    s_waitcnt vmcnt(1)
    s_branch L_ffn_nxo2
L_ffn_nxo:
    s_nop 7
    s_waitcnt vmcnt(0)
L_ffn_nxo2:
    v_fmac_f32 v80, v34, v96
    v_fmac_f32 v81, v34, v97
    v_fmac_f32 v82, v34, v98
    v_fmac_f32 v83, v34, v99
    v_fmac_f32 v84, v35, v100
    v_fmac_f32 v85, v35, v101
    v_fmac_f32 v86, v35, v102
    v_fmac_f32 v87, v35, v103
    v_fmac_f32 v88, v36, v104
    v_fmac_f32 v89, v36, v105
    v_fmac_f32 v90, v36, v106
    v_fmac_f32 v91, v36, v107
    v_fmac_f32 v92, v37, v108
    v_fmac_f32 v93, v37, v109
    v_fmac_f32 v94, v37, v110
    v_fmac_f32 v95, v37, v111
    s_mov_b32 s61, 0x20000
    s_waitcnt vmcnt(1)
L_ffn_s7:
    v_max3_u32 v44, v144, v145, v146
    v_max3_u32 v45, v147, v148, v149
    v_max3_u32 v44, v44, v150, v151
    v_max_u32 v44, v44, v45
    v_cmp_eq_u32 vcc, -1, v44
    s_sub_u32 s61, s61, 1
    s_nop 0
    s_cmp_eq_u64 vcc, 0
    s_cbranch_scc1 L_ffn_s7_x
    s_cmp_eq_u32 s61, 0
    s_cbranch_scc1 L_ffn_s7_x
    s_add_u32 s57, s34, 1
    s_and_b32 s57, s57, 7
    s_mul_i32 s46, s57, 2359296
    s_add_u32 s46, s46, s73
    s_add_u32 s46, s46, 7471104
    buffer_load_dwordx4 v[144:147], v32, s[24:27], s46 offen sc1
    buffer_load_dwordx4 v[148:151], v32, s[24:27], s46 offen offset:1024 sc1
    s_waitcnt vmcnt(0)
    s_branch L_ffn_s7
L_ffn_s7_x:
    v_lshlrev_b32 v44, 16, v144
    v_and_b32 v45, s58, v144
    v_fmac_f32 v80, v34, v44
    v_fmac_f32 v81, v34, v45
    v_lshlrev_b32 v44, 16, v145
    v_and_b32 v45, s58, v145
    v_fmac_f32 v82, v34, v44
    v_fmac_f32 v83, v34, v45
    v_lshlrev_b32 v44, 16, v146
    v_and_b32 v45, s58, v146
    v_fmac_f32 v84, v35, v44
    v_fmac_f32 v85, v35, v45
    v_lshlrev_b32 v44, 16, v147
    v_and_b32 v45, s58, v147
    v_fmac_f32 v86, v35, v44
    v_fmac_f32 v87, v35, v45
    v_cvt_pk_bf16_f32 v64, v80, v81
    v_cvt_pk_bf16_f32 v65, v82, v83
    v_cvt_pk_bf16_f32 v66, v84, v85
    v_cvt_pk_bf16_f32 v67, v86, v87
    s_nop 1
    v_permlane16_swap_b32 v64, v66
    v_permlane16_swap_b32 v65, v67
    buffer_store_dwordx4 v[64:67], v23, s[20:23], s76 offen sc1
    v_lshlrev_b32 v44, 16, v148
    v_and_b32 v45, s58, v148
    v_fmac_f32 v88, v36, v44
    v_fmac_f32 v89, v36, v45
    v_lshlrev_b32 v44, 16, v149
    v_and_b32 v45, s58, v149
    v_fmac_f32 v90, v36, v44
    v_fmac_f32 v91, v36, v45
    v_lshlrev_b32 v44, 16, v150
    v_and_b32 v45, s58, v150
    v_fmac_f32 v92, v37, v44
    v_fmac_f32 v93, v37, v45
    v_lshlrev_b32 v44, 16, v151
    v_and_b32 v45, s58, v151
    v_fmac_f32 v94, v37, v44
    v_fmac_f32 v95, v37, v45
    v_cvt_pk_bf16_f32 v68, v88, v89
    v_cvt_pk_bf16_f32 v69, v90, v91
    v_cvt_pk_bf16_f32 v70, v92, v93
    v_cvt_pk_bf16_f32 v71, v94, v95
    s_nop 1
    v_permlane16_swap_b32 v68, v70
    v_permlane16_swap_b32 v69, v71
    buffer_store_dwordx4 v[68:71], v23, s[20:23], s3 offen sc1
L_ffn_end:
    s_endpgm
L_ffn_h1_r:
    s_sub_u32 s61, s61, 1
    s_cmp_eq_u32 s61, 0
    s_cbranch_scc1 L_ffn_h1_x
    s_add_u32 s57, s34, 1
    s_and_b32 s57, s57, 7
    s_lshl_b32 s57, s57, 13
    s_add_u32 s57, s57, s66
    s_add_u32 s57, s57, 5111808
    buffer_load_dwordx4 v[160:163], v32, s[24:27], s57 offen sc1
    buffer_load_dwordx4 v[164:167], v32, s[24:27], s57 offen offset:1024 sc1
    s_waitcnt vmcnt(0)
    s_branch L_ffn_h1
L_ffn_h2_r:
    s_sub_u32 s61, s61, 1
    s_cmp_eq_u32 s61, 0
    s_cbranch_scc1 L_ffn_h2_x
    s_add_u32 s57, s34, 2
    s_and_b32 s57, s57, 7
    s_lshl_b32 s57, s57, 13
    s_add_u32 s57, s57, s66
    s_add_u32 s57, s57, 5111808
    buffer_load_dwordx4 v[168:171], v32, s[24:27], s57 offen sc1
    buffer_load_dwordx4 v[172:175], v32, s[24:27], s57 offen offset:1024 sc1
    s_waitcnt vmcnt(0)
    s_branch L_ffn_h2
L_ffn_h3_r:
    s_sub_u32 s61, s61, 1
    s_cmp_eq_u32 s61, 0
    s_cbranch_scc1 L_ffn_h3_x
    s_add_u32 s57, s34, 3
    s_and_b32 s57, s57, 7
    s_lshl_b32 s57, s57, 13
    s_add_u32 s57, s57, s66
    s_add_u32 s57, s57, 5111808
    buffer_load_dwordx4 v[176:179], v32, s[24:27], s57 offen sc1
    buffer_load_dwordx4 v[180:183], v32, s[24:27], s57 offen offset:1024 sc1
    s_waitcnt vmcnt(0)
    s_branch L_ffn_h3
L_ffn_h4_r:
    s_sub_u32 s61, s61, 1
    s_cmp_eq_u32 s61, 0
    s_cbranch_scc1 L_ffn_h4_x
    s_add_u32 s57, s34, 4
    s_and_b32 s57, s57, 7
    s_lshl_b32 s57, s57, 13
    s_add_u32 s57, s57, s66
    s_add_u32 s57, s57, 5111808
    buffer_load_dwordx4 v[184:187], v32, s[24:27], s57 offen sc1
    buffer_load_dwordx4 v[188:191], v32, s[24:27], s57 offen offset:1024 sc1
    s_waitcnt vmcnt(0)
    s_branch L_ffn_h4
L_ffn_h5_r:
    s_sub_u32 s61, s61, 1
    s_cmp_eq_u32 s61, 0
    s_cbranch_scc1 L_ffn_h5_x
    s_add_u32 s57, s34, 5
    s_and_b32 s57, s57, 7
    s_lshl_b32 s57, s57, 13
    s_add_u32 s57, s57, s66
    s_add_u32 s57, s57, 5111808
    buffer_load_dwordx4 v[192:195], v32, s[24:27], s57 offen sc1
    buffer_load_dwordx4 v[196:199], v32, s[24:27], s57 offen offset:1024 sc1
    s_waitcnt vmcnt(0)
    s_branch L_ffn_h5
L_ffn_h6_r:
    s_sub_u32 s61, s61, 1
    s_cmp_eq_u32 s61, 0
    s_cbranch_scc1 L_ffn_h6_x
    s_add_u32 s57, s34, 6
    s_and_b32 s57, s57, 7
    s_lshl_b32 s57, s57, 13
    s_add_u32 s57, s57, s66
    s_add_u32 s57, s57, 5111808
    buffer_load_dwordx4 v[200:203], v32, s[24:27], s57 offen sc1
    buffer_load_dwordx4 v[204:207], v32, s[24:27], s57 offen offset:1024 sc1
    s_waitcnt vmcnt(0)
    s_branch L_ffn_h6
L_ffn_h7_r:
    s_sub_u32 s61, s61, 1
    s_cmp_eq_u32 s61, 0
    s_cbranch_scc1 L_ffn_h7_x
    s_add_u32 s57, s34, 7
    s_and_b32 s57, s57, 7
    s_lshl_b32 s57, s57, 13
    s_add_u32 s57, s57, s66
    s_add_u32 s57, s57, 5111808
    buffer_load_dwordx4 v[208:211], v32, s[24:27], s57 offen sc1
    buffer_load_dwordx4 v[212:215], v32, s[24:27], s57 offen offset:1024 sc1
    s_waitcnt vmcnt(0)
    s_branch L_ffn_h7
L_ffn_pa_r:
    s_mov_b64 exec, 0xff
    buffer_load_dword v6, v5, s[24:27], s59 offen sc1
    buffer_load_dword v7, v5, s[24:27], s56 offen sc1
    s_mov_b64 exec, -1
    s_waitcnt vmcnt(0)
    s_branch L_ffn_pa
.section .rodata,"a"
.p2align 6
.amdhsa_kernel ffn_kernel
  .amdhsa_next_free_vgpr 512
  .amdhsa_next_free_sgpr 96
  .amdhsa_accum_offset 256
  .amdhsa_group_segment_fixed_size 0
  .amdhsa_kernarg_size 104
  .amdhsa_user_sgpr_count 2
  .amdhsa_user_sgpr_kernarg_segment_ptr 1
  .amdhsa_system_sgpr_workgroup_id_x 1
.end_amdhsa_kernel
```
